```python
import torch

def _softmax(x, axis=-1):
    return torch.softmax(x, dim=axis)
def _gelu(x):
    return torch.nn.functional.gelu(x, approximate="tanh")
def _silu(x):
    return torch.nn.functional.silu(x)
def _sigmoid(x):
    return torch.sigmoid(x)
def _layernorm(x, axis=-1, eps=1e-5):
    m = x.mean(dim=axis, keepdim=True)
    v = x.var(dim=axis, keepdim=True, unbiased=False)
    return (x - m) / torch.sqrt(v + eps)
def _scatter_add(tgt, idx, src, axis=0):
    return tgt.clone().index_add_(axis, idx, src)
def _segment_sum(src, seg, n):
    out = torch.zeros((n,) + src.shape[1:], dtype=src.dtype)
    return out.index_add_(0, seg, src)
def _pad(x, pw):
    flat = tuple(v for pair in reversed(pw) for v in pair)
    return torch.nn.functional.pad(x, flat)

kernel_name = 'sequential_preLN__sliding_block_cached__glu_gated_bilinear__decode'

def setup_inputs():

    _w = (lambda a: (lambda t: t.to(torch.bfloat16) if t.is_floating_point() else t)(torch.as_tensor(a)))
    def _A_setup():
        B, Sq, D = 8, 1, 512
        Hq, Hkv, Sk, Dh = 32, 8, 8192, 128
        assert Hq % Hkv == 0, (Hq, Hkv)
        return {
            "x": _w((lambda *s: torch.randn(*s, dtype=torch.bfloat16) * 0.05)(B, Sq, D)),
            "k_cache": _w((lambda *s: torch.randn(*s, dtype=torch.bfloat16) * 1.6)(B, Hkv, Sk, Dh)),
            "v_cache": _w((lambda *s: torch.randn(*s, dtype=torch.bfloat16) * 0.8)(B, Hkv, Sk, Dh)),
            "wq": _w((lambda *s: torch.randn(*s, dtype=torch.bfloat16) * 1.6)(D, Hq * Dh) * (D ** -0.5)),
            "wo": _w((lambda *s: torch.randn(*s, dtype=torch.bfloat16) * 0.8)(Hq * Dh, D) * ((Hq * Dh) ** -0.5)),
        }
    _A_in = _A_setup()

    def _B_setup():
        B, S, D, F = 8, 1, 512, 1792
        return {
            "x": _w((lambda *s: torch.randn(*s, dtype=torch.bfloat16) * 0.05)(B, S, D)),
            "w_gate": _w((lambda *s: torch.randn(*s, dtype=torch.bfloat16) * 0.4)(D, F) * (D ** -0.5)),
            "w_up": _w((lambda *s: torch.randn(*s, dtype=torch.bfloat16) * 0.4)(D, F) * (D ** -0.5)),
            "w_down": _w((lambda *s: torch.randn(*s, dtype=torch.bfloat16) * 0.4)(F, D) * (F ** -0.5)),
        }
    _B_in = _B_setup()

    return {
        "A_x": _A_in["x"],
        "A_k_cache": _A_in["k_cache"],
        "A_v_cache": _A_in["v_cache"],
        "A_wq": _A_in["wq"],
        "A_wo": _A_in["wo"],
        "B_x": _B_in["x"],
        "B_w_gate": _B_in["w_gate"],
        "B_w_up": _B_in["w_up"],
        "B_w_down": _B_in["w_down"],
    }

def reference(A_x, A_k_cache, A_v_cache, A_wq, A_wo, B_x, B_w_gate, B_w_up, B_w_down):
    def _A_ref(x, k_cache, v_cache, wq, wo):
        B, Sq, D = x.shape
        Hq, Dh = 32, 128
        Hkv, Sk = k_cache.shape[1], k_cache.shape[2]
        W = min(4096, max(256, Sk // 4))
        rep = Hq // Hkv
        q = (lambda x, *d: x.permute(*d))((x @ wq).reshape(B, Sq, Hq, Dh), 0, 2, 1, 3)
        k = (lambda x, n, axis: torch.repeat_interleave(x, n, dim=axis))(k_cache[:, :, Sk - W:, :], rep, axis=1)
        v = (lambda x, n, axis: torch.repeat_interleave(x, n, dim=axis))(v_cache[:, :, Sk - W:, :], rep, axis=1)
        scores = torch.einsum("bhqd,bhkd->bhqk", q, k) * (Dh ** -0.5)
        p = _softmax(scores, axis=-1)
        o = torch.einsum("bhqk,bhkd->bhqd", p, v)
        return (lambda x, *d: x.permute(*d))(o, 0, 2, 1, 3).reshape(B, Sq, Hq * Dh) @ wo

    def _B_ref(x, w_gate, w_up, w_down):
        g = torch.einsum("bsd,df->bsf", x, w_gate)
        u = torch.einsum("bsd,df->bsf", x, w_up)
        h = g * u
        return torch.einsum("bsf,fd->bsd", h, w_down)

    x = A_x
    h = x + _A_ref(_layernorm(x, axis=-1), A_k_cache, A_v_cache, A_wq, A_wo)
    h2 = h + _B_ref(_layernorm(h, axis=-1), B_w_gate, B_w_up, B_w_down)
    return h2
```

```asm
; @launch grid=(256,1,1) block=(576,1,1) lds=128000
.amdgcn_target "amdgcn-amd-amdhsa--gfx950"
.text
.globl sequential_preLN__sliding_block_cached__glu_gated_bilinear__decode_kernel
.p2align 8
.type sequential_preLN__sliding_block_cached__glu_gated_bilinear__decode_kernel,@function
sequential_preLN__sliding_block_cached__glu_gated_bilinear__decode_kernel:
    s_cmp_ge_u32 s2, 256
    s_cbranch_scc1 L_end
    s_load_dwordx2 s[8:9], s[0:1], 8
    s_load_dwordx2 s[12:13], s[0:1], 16
    s_load_dwordx2 s[16:17], s[0:1], 0
    s_load_dwordx2 s[20:21], s[0:1], 24
    s_load_dwordx2 s[24:25], s[0:1], 88
    v_readfirstlane_b32 s44, v0
    v_lshlrev_b32 v9, 2, v0
    v_mov_b32 v12, -1
    ds_write_b32 v9, v12
    s_lshr_b32 s44, s44, 6
    s_cmp_eq_u32 s44, 8
    s_cbranch_scc1 L_helper
    s_and_b32 s4, s2, 7
    s_lshr_b32 s5, s2, 3
    s_lshr_b32 s6, s5, 2
    s_and_b32 s7, s5, 3
    v_and_b32 v1, 63, v0
    v_and_b32 v2, 15, v0
    v_bfe_u32 v3, v0, 4, 2
    v_lshlrev_b32 v4, 4, v1
    v_and_b32 v6, 3, v0
    s_mov_b32 s10, 134217728
    s_mov_b32 s11, 0x20000
    s_mov_b32 s14, 134217728
    s_mov_b32 s15, 0x20000
    s_lshl_b32 s3, s6, 3
    s_add_u32 s3, s3, s4
    s_lshl_b32 s3, s3, 21
    s_lshl_b32 s55, s7, 17
    s_add_u32 s3, s3, s55
    s_add_u32 s3, s3, 1572864
    s_add_u32 s55, s44, s5
    s_add_u32 s57, s5, 0
    s_and_b32 s57, s57, 24
    s_lshl_b32 s57, s57, 12
    s_add_u32 s45, s57, s3
    s_add_u32 s57, s5, 8
    s_and_b32 s57, s57, 24
    s_lshl_b32 s57, s57, 12
    s_add_u32 s46, s57, s3
    s_add_u32 s57, s5, 16
    s_and_b32 s57, s57, 24
    s_lshl_b32 s57, s57, 12
    s_add_u32 s47, s57, s3
    s_add_u32 s57, s5, 24
    s_and_b32 s57, s57, 24
    s_lshl_b32 s57, s57, 12
    s_add_u32 s48, s57, s3
    s_lshl_b32 s101, s55, 12
    v_lshrrev_b32 v5, 2, v2
    v_lshlrev_b32 v5, 8, v5
    v_lshl_add_u32 v5, v3, 6, v5
    v_lshl_add_u32 v5, v6, 4, v5
    v_and_b32 v9, 7, v1
    v_bfe_u32 v7, v1, 3, 1
    v_lshlrev_b32 v7, 19, v7
    v_lshl_add_u32 v7, v3, 16, v7
    v_lshl_add_u32 v7, v9, 4, v7
    s_lshr_b32 s59, s5, 3
    s_lshl_b32 s59, s59, 20
    s_lshl_b32 s60, s4, 10
    s_add_u32 s59, s59, s60
    s_and_b32 s60, s5, 7
    s_lshl_b32 s60, s60, 7
    s_add_u32 s59, s59, s60
    s_lshl_b32 s60, s44, 13
    s_add_u32 s59, s59, s60
    s_add_u32 s58, s59, 262144
    s_lshl_b32 s61, s44, 10
    s_mul_i32 s62, s44, 1040
    s_add_u32 m0, s62, 34560
    s_mov_b32 s18, 8192
    s_mov_b32 s19, 0x20000
    s_mov_b32 s22, 4194304
    s_mov_b32 s23, 0x20000
    s_waitcnt lgkmcnt(0)
    buffer_load_dwordx4 v4, s[16:19], s61 offen lds
    s_add_u32 m0, s61, 60416
    s_nop 0
    buffer_load_dwordx4 v7, s[20:23], s59 offen nt lds
    s_add_u32 m0, s61, 68608
    s_nop 0
    buffer_load_dwordx4 v7, s[20:23], s58 offen nt lds
    s_add_u32 s63, s101, 0
    s_and_b32 s63, s63, 0x7000
    s_add_u32 s63, s63, s45
    buffer_load_dwordx4 v[16:19], v5, s[8:11], s63 offen offset:0 nt
    s_add_u32 s63, s101, 4096
    s_and_b32 s63, s63, 0x7000
    s_add_u32 s63, s63, s45
    buffer_load_dwordx4 v[20:23], v5, s[8:11], s63 offen offset:1024 nt
    s_load_dwordx2 s[20:21], s[0:1], 32
    s_load_dwordx2 s[32:33], s[0:1], 48
    s_load_dwordx2 s[40:41], s[0:1], 56
    s_load_dwordx2 s[36:37], s[0:1], 64
    s_mov_b32 s34, 1835008
    s_mov_b32 s35, 0x20000
    s_mov_b32 s42, 1835008
    s_mov_b32 s43, 0x20000
    s_mov_b32 s38, 1835008
    s_mov_b32 s39, 0x20000
    s_mov_b32 s26, 2621440
    s_mov_b32 s27, 0x20000
    v_lshlrev_b32 v11, 2, v1
    s_mov_b32 s53, 0x05040100
    s_mov_b32 s54, 0x07060302
    s_and_b32 s49, s7, 1
    s_lshl_b32 s55, s6, 1
    s_add_u32 s49, s49, s55
    v_lshrrev_b32 v12, 3, v1
    v_and_b32 v13, 7, v1
    v_and_b32 v9, 4, v12
    v_bfe_u32 v8, v12, 1, 1
    v_or_b32 v9, v9, v8
    v_and_b32 v8, 1, v12
    v_lshl_add_u32 v9, v8, 1, v9
    v_lshlrev_b32 v9, 10, v9
    v_lshl_add_u32 v167, v13, 4, v9
    s_lshl_b32 s52, s4, 19
    s_lshl_b32 s60, s44, 16
    s_add_u32 s52, s52, s60
    s_mul_i32 s100, s44, 8448
    s_add_u32 s100, s100, 60416
    s_barrier
    s_add_u32 s63, s101, 8192
    s_and_b32 s63, s63, 0x7000
    s_add_u32 s63, s63, s45
    buffer_load_dwordx4 v[24:27], v5, s[8:11], s63 offen offset:2048 nt
    s_add_u32 s63, s101, 12288
    s_and_b32 s63, s63, 0x7000
    s_add_u32 s63, s63, s45
    buffer_load_dwordx4 v[28:31], v5, s[8:11], s63 offen offset:3072 nt
    s_waitcnt vmcnt(4)
    v_mov_b32 v12, 0
    v_mov_b32 v13, 1
    s_mov_b64 exec, 1
    ds_add_u32 v12, v13 offset:1300
    s_mov_b64 exec, -1
    s_waitcnt vmcnt(3)
    s_add_u32 s63, s101, 16384
    s_and_b32 s63, s63, 0x7000
    s_add_u32 s63, s63, s46
    buffer_load_dwordx4 v[32:35], v5, s[8:11], s63 offen offset:0 nt
    s_waitcnt vmcnt(3)
    s_add_u32 s63, s101, 20480
    s_and_b32 s63, s63, 0x7000
    s_add_u32 s63, s63, s46
    buffer_load_dwordx4 v[36:39], v5, s[8:11], s63 offen offset:1024 nt
    s_waitcnt vmcnt(3)
    s_add_u32 s63, s101, 24576
    s_and_b32 s63, s63, 0x7000
    s_add_u32 s63, s63, s46
    buffer_load_dwordx4 v[40:43], v5, s[8:11], s63 offen offset:2048 nt
    s_waitcnt vmcnt(3)
    s_add_u32 s63, s101, 28672
    s_and_b32 s63, s63, 0x7000
    s_add_u32 s63, s63, s46
    buffer_load_dwordx4 v[44:47], v5, s[8:11], s63 offen offset:3072 nt
    s_waitcnt vmcnt(3)
    s_add_u32 s63, s101, 0
    s_and_b32 s63, s63, 0x7000
    s_add_u32 s63, s63, s47
    buffer_load_dwordx4 v[48:51], v5, s[8:11], s63 offen offset:0 nt
    s_waitcnt vmcnt(3)
    s_add_u32 s63, s101, 4096
    s_and_b32 s63, s63, 0x7000
    s_add_u32 s63, s63, s47
    buffer_load_dwordx4 v[52:55], v5, s[8:11], s63 offen offset:1024 nt
    s_waitcnt vmcnt(3)
    s_add_u32 s63, s101, 8192
    s_and_b32 s63, s63, 0x7000
    s_add_u32 s63, s63, s47
    buffer_load_dwordx4 v[56:59], v5, s[8:11], s63 offen offset:2048 nt
    ds_write_b32 v12, v12 offset:1308
    s_waitcnt vmcnt(3)
    s_add_u32 s63, s101, 12288
    s_and_b32 s63, s63, 0x7000
    s_add_u32 s63, s63, s47
    buffer_load_dwordx4 v[60:63], v5, s[8:11], s63 offen offset:3072 nt
    s_waitcnt vmcnt(3)
    s_add_u32 s63, s101, 16384
    s_and_b32 s63, s63, 0x7000
    s_add_u32 s63, s63, s48
    buffer_load_dwordx4 v[64:67], v5, s[8:11], s63 offen offset:0 nt
    s_waitcnt vmcnt(3)
    s_add_u32 s63, s101, 20480
    s_and_b32 s63, s63, 0x7000
    s_add_u32 s63, s63, s48
    buffer_load_dwordx4 v[68:71], v5, s[8:11], s63 offen offset:1024 nt
    s_waitcnt vmcnt(3)
    s_add_u32 s63, s101, 24576
    s_and_b32 s63, s63, 0x7000
    s_add_u32 s63, s63, s48
    buffer_load_dwordx4 v[72:75], v5, s[8:11], s63 offen offset:2048 nt
    s_waitcnt vmcnt(3)
    s_add_u32 s63, s101, 28672
    s_and_b32 s63, s63, 0x7000
    s_add_u32 s63, s63, s48
    buffer_load_dwordx4 v[76:79], v5, s[8:11], s63 offen offset:3072 nt
    s_waitcnt vmcnt(3)
    s_add_u32 s63, s101, 0
    s_and_b32 s63, s63, 0x7000
    s_add_u32 s63, s63, s45
    buffer_load_dwordx4 v[80:83], v4, s[12:15], s63 offen offset:0 nt
    s_waitcnt vmcnt(3)
    s_add_u32 s63, s101, 4096
    s_and_b32 s63, s63, 0x7000
    s_add_u32 s63, s63, s45
    buffer_load_dwordx4 v[84:87], v4, s[12:15], s63 offen offset:1024 nt
    s_waitcnt vmcnt(3)
    s_add_u32 s63, s101, 8192
    s_and_b32 s63, s63, 0x7000
    s_add_u32 s63, s63, s45
    buffer_load_dwordx4 v[88:91], v4, s[12:15], s63 offen offset:2048 nt
    s_waitcnt vmcnt(3)
    s_add_u32 s63, s101, 12288
    s_and_b32 s63, s63, 0x7000
    s_add_u32 s63, s63, s45
    buffer_load_dwordx4 v[92:95], v4, s[12:15], s63 offen offset:3072 nt
    s_add_u32 s63, s101, 16384
    s_and_b32 s63, s63, 0x7000
    s_add_u32 s63, s63, s46
    buffer_load_dwordx4 v[96:99], v4, s[12:15], s63 offen offset:0 nt
    s_branch L_att2
L_helper:
    s_setprio 3
    s_and_b32 s4, s2, 7
    s_lshr_b32 s5, s2, 3
    s_lshr_b32 s6, s5, 2
    s_and_b32 s7, s5, 3
    v_and_b32 v1, 63, v0
    v_and_b32 v2, 15, v0
    v_bfe_u32 v3, v0, 4, 2
    v_lshlrev_b32 v4, 4, v1
    v_and_b32 v6, 3, v0
    s_lshr_b32 s57, s5, 3
    s_and_b32 s58, s5, 7
    v_and_b32 v9, 7, v1
    s_waitcnt lgkmcnt(0)
    s_barrier
    s_mov_b32 s26, 2621440
    s_mov_b32 s27, 0x20000
    s_mov_b64 exec, 1
    buffer_load_dword v115, v4, s[24:27], 0 offen sc1
    s_mov_b64 exec, -1
    v_lshlrev_b32 v11, 2, v1
    s_mov_b32 s53, 0x05040100
    s_mov_b32 s54, 0x07060302
    s_and_b32 s49, s7, 1
    s_lshl_b32 s55, s6, 1
    s_add_u32 s49, s49, s55
    s_lshl_b32 s56, s4, 5
    s_add_u32 s56, s56, s5
    v_mov_b32 v13, -1
    v_mov_b32 v14, -1
    v_mov_b32 v15, -1
    s_lshl_b32 s50, s56, 7
    s_add_u32 s50, s50, 32768
    s_lshr_b32 s48, s56, 2
    s_lshl_b32 s48, s48, 12
    s_add_u32 s48, s48, 65536
    s_lshl_b32 s45, s7, 10
    s_add_u32 s45, s45, s48
    buffer_store_dwordx4 v[12:15], v4, s[24:27], s45 offen
    s_lshl_b32 s46, s4, 13
    s_lshl_b32 s60, s49, 9
    s_add_u32 s46, s46, s60
    s_add_u32 s46, s46, 1376256
    s_cmp_ge_u32 s7, 2
    s_cselect_b32 s46, s46, 0x80000000
    s_mov_b32 exec_hi, 0
    buffer_store_dwordx4 v[12:15], v4, s[24:27], s46 offen
    s_mov_b64 exec, 0xff
    buffer_store_dwordx4 v[12:15], v4, s[24:27], s50 offen
    s_mov_b64 exec, 15
    s_getpc_b64 s[60:61]
L_pc:
    s_sub_u32 s60, s60, (L_pc - sequential_preLN__sliding_block_cached__glu_gated_bilinear__decode_kernel)
    s_subb_u32 s61, s61, 0
    s_lshl_b32 s62, s5, 9
    v_lshlrev_b32 v10, 7, v1
    v_add_u32 v10, s62, v10
    v_min_u32 v10, (L_last - sequential_preLN__sliding_block_cached__glu_gated_bilinear__decode_kernel), v10
    global_load_dword v112, v10, s[60:61]
    s_mov_b64 exec, -1
    v_lshrrev_b32 v5, 1, v2
    v_mul_u32_u24 v5, 1040, v5
    v_and_b32 v10, 1, v1
    v_lshl_add_u32 v5, v10, 7, v5
    v_lshl_add_u32 v5, v3, 4, v5
    v_mov_b32 v7, 0
    s_mov_b32 s55, 0
L_xc:
    ds_read_b32 v10, v7 offset:1300
    s_add_u32 s55, s55, 1
    s_waitcnt lgkmcnt(0)
    v_cmp_ne_u32 vcc, 7, v10
    s_cbranch_vccz L_xc_ok
    s_cmp_lt_u32 s55, 40000000
    s_cbranch_scc1 L_xc
L_xc_ok:
    v_add_u32 v7, 60416, v4
    s_add_u32 s60, s57, 0
    s_and_b32 s60, s60, 3
    s_lshl_b32 s60, s60, 8
    v_add_u32 v10, s60, v5
    ds_read_b128 v[16:19], v10 offset:34560
    ds_read_b128 v[20:23], v10 offset:34624
    s_add_u32 s60, s57, 1
    s_and_b32 s60, s60, 3
    s_lshl_b32 s60, s60, 8
    v_add_u32 v10, s60, v5
    ds_read_b128 v[24:27], v10 offset:34560
    ds_read_b128 v[28:31], v10 offset:34624
    s_add_u32 s60, s57, 2
    s_and_b32 s60, s60, 3
    s_lshl_b32 s60, s60, 8
    v_add_u32 v10, s60, v5
    ds_read_b128 v[32:35], v10 offset:34560
    ds_read_b128 v[36:39], v10 offset:34624
    s_add_u32 s60, s57, 3
    s_and_b32 s60, s60, 3
    s_lshl_b32 s60, s60, 8
    v_add_u32 v10, s60, v5
    ds_read_b128 v[40:43], v10 offset:34560
    ds_read_b128 v[44:47], v10 offset:34624
    v_mov_b32 v116, 0x3f803f80
    v_mov_b32 v117, 0x3f803f80
    v_mov_b32 v118, 0x3f803f80
    v_mov_b32 v119, 0x3f803f80
    s_getreg_b32 s52, hwreg(HW_REG_XCC_ID)
    s_and_b32 s52, s52, 15
    s_waitcnt lgkmcnt(0)
    ds_read_b128 v[48:51], v7 offset:0
    ds_read_b128 v[52:55], v7 offset:1024
    ds_read_b128 v[56:59], v7 offset:2048
    ds_read_b128 v[60:63], v7 offset:3072
    ds_read_b128 v[64:67], v7 offset:4096
    ds_read_b128 v[68:71], v7 offset:5120
    ds_read_b128 v[72:75], v7 offset:6144
    ds_read_b128 v[76:79], v7 offset:7168
    ds_read_b128 v[80:83], v7 offset:8192
    ds_read_b128 v[84:87], v7 offset:9216
    ds_read_b128 v[88:91], v7 offset:10240
    ds_read_b128 v[92:95], v7 offset:11264
    s_waitcnt lgkmcnt(8)
    ds_read_b128 v[96:99], v7 offset:12288
    ds_read_b128 v[100:103], v7 offset:13312
    ds_read_b128 v[104:107], v7 offset:14336
    ds_read_b128 v[108:111], v7 offset:15360
    v_mfma_f32_16x16x32_bf16 v[120:123], v[116:119], v[16:19], 0
    v_mfma_f32_16x16x32_bf16 v[124:127], v[16:19], v[16:19], 0
    v_mfma_f32_16x16x32_bf16 v[120:123], v[116:119], v[20:23], v[120:123]
    v_mfma_f32_16x16x32_bf16 v[124:127], v[20:23], v[20:23], v[124:127]
    v_mfma_f32_16x16x32_bf16 v[120:123], v[116:119], v[24:27], v[120:123]
    v_mfma_f32_16x16x32_bf16 v[124:127], v[24:27], v[24:27], v[124:127]
    v_mfma_f32_16x16x32_bf16 v[120:123], v[116:119], v[28:31], v[120:123]
    v_mfma_f32_16x16x32_bf16 v[124:127], v[28:31], v[28:31], v[124:127]
    v_mfma_f32_16x16x32_bf16 v[120:123], v[116:119], v[32:35], v[120:123]
    v_mfma_f32_16x16x32_bf16 v[124:127], v[32:35], v[32:35], v[124:127]
    v_mfma_f32_16x16x32_bf16 v[120:123], v[116:119], v[36:39], v[120:123]
    v_mfma_f32_16x16x32_bf16 v[124:127], v[36:39], v[36:39], v[124:127]
    v_mfma_f32_16x16x32_bf16 v[120:123], v[116:119], v[40:43], v[120:123]
    v_mfma_f32_16x16x32_bf16 v[124:127], v[40:43], v[40:43], v[124:127]
    v_mfma_f32_16x16x32_bf16 v[120:123], v[116:119], v[44:47], v[120:123]
    v_mfma_f32_16x16x32_bf16 v[124:127], v[44:47], v[44:47], v[124:127]
    s_waitcnt vmcnt(0)
    v_readfirstlane_b32 s28, v115
    s_nop 3
    s_add_u32 s28, s28, 0x9E377111
    s_and_b32 s60, s28, 15
    s_xor_b32 s61, s60, 15
    s_lshl_b32 s61, s61, 4
    s_or_b32 s60, s60, s61
    s_and_b32 s61, s28, 0xff0
    s_lshl_b32 s61, s61, 4
    s_or_b32 s29, s60, s61
    s_and_b32 s96, s29, 15
    s_bfe_u32 s97, s29, 0x40004
    s_bfe_u32 s98, s29, 0x40008
    s_bfe_u32 s99, s29, 0x4000c
    s_xor_b32 s99, s99, s52
    v_cmp_eq_u32 vcc, 1, v6
    v_cmp_eq_u32 s[60:61], 2, v6
    v_cmp_eq_u32 s[62:63], 3, v6
    v_lshrrev_b32 v15, 2, v2
    v_lshl_add_u32 v15, v15, 4, v2
    v_lshlrev_b32 v15, 2, v15
    v_cndmask_b32 v124, v124, v125, vcc
    v_cndmask_b32 v124, v124, v126, s[60:61]
    v_cndmask_b32 v124, v124, v127, s[62:63]
    ds_bpermute_b32 v124, v15, v124
    s_lshl_b32 s60, s57, 11
    s_lshl_b32 s57, s4, 16
    s_add_u32 s57, s57, s60
    s_lshl_b32 s60, s58, 8
    s_add_u32 s57, s57, s60
    s_add_u32 s57, s57, 1572864
    v_lshrrev_b32 v8, 3, v1
    v_lshlrev_b32 v8, 13, v8
    v_lshl_add_u32 v8, v9, 4, v8
    s_lshl_b32 s51, s4, 3
    s_add_u32 s51, s51, s6
    s_lshl_b32 s51, s51, 13
    s_add_u32 s51, s51, 1572864
    s_waitcnt lgkmcnt(0)
    s_nop 0
    v_add_f32_dpp v120, v120, v120 quad_perm:[1,0,3,2] row_mask:0xf bank_mask:0xf
    v_add_f32_dpp v124, v124, v124 quad_perm:[1,0,3,2] row_mask:0xf bank_mask:0xf
    v_mul_f32 v120, 0x3b000000, v120
    v_mul_f32 v124, 0x3b000000, v124
    v_fma_f32 v124, -v120, v120, v124
    v_max_f32 v124, 0, v124
    v_cvt_pk_bf16_f32 v121, v120, v124
    v_lshlrev_b32 v120, 16, v121
    v_and_b32 v124, 0xffff0000, v121
    v_add_f32 v124, 0x3727c5ac, v124
    v_cvt_pk_bf16_f32 v121, v124, v124
    v_lshlrev_b32 v124, 16, v121
    v_sqrt_f32 v124, v124
    s_nop 0
    v_cvt_pk_bf16_f32 v121, v124, v124
    v_lshlrev_b32 v124, 16, v121
    v_rcp_f32 v124, v124
    v_lshlrev_b32 v24, 16, v16
    v_and_b32 v25, 0xffff0000, v16
    v_lshlrev_b32 v26, 16, v17
    v_and_b32 v27, 0xffff0000, v17
    v_lshlrev_b32 v28, 16, v18
    v_and_b32 v29, 0xffff0000, v18
    v_lshlrev_b32 v30, 16, v19
    v_and_b32 v31, 0xffff0000, v19
    v_lshlrev_b32 v32, 16, v20
    v_and_b32 v33, 0xffff0000, v20
    v_lshlrev_b32 v34, 16, v21
    v_and_b32 v35, 0xffff0000, v21
    v_lshlrev_b32 v36, 16, v22
    v_and_b32 v37, 0xffff0000, v22
    v_lshlrev_b32 v38, 16, v23
    v_and_b32 v39, 0xffff0000, v23
    v_sub_f32 v24, v24, v120
    v_sub_f32 v25, v25, v120
    v_sub_f32 v26, v26, v120
    v_sub_f32 v27, v27, v120
    v_sub_f32 v28, v28, v120
    v_sub_f32 v29, v29, v120
    v_sub_f32 v30, v30, v120
    v_sub_f32 v31, v31, v120
    v_sub_f32 v32, v32, v120
    v_sub_f32 v33, v33, v120
    v_sub_f32 v34, v34, v120
    v_sub_f32 v35, v35, v120
    v_sub_f32 v36, v36, v120
    v_sub_f32 v37, v37, v120
    v_sub_f32 v38, v38, v120
    v_sub_f32 v39, v39, v120
    v_cvt_pk_bf16_f32 v16, v24, v25
    v_cvt_pk_bf16_f32 v17, v26, v27
    v_cvt_pk_bf16_f32 v18, v28, v29
    v_cvt_pk_bf16_f32 v19, v30, v31
    v_cvt_pk_bf16_f32 v20, v32, v33
    v_cvt_pk_bf16_f32 v21, v34, v35
    v_cvt_pk_bf16_f32 v22, v36, v37
    v_cvt_pk_bf16_f32 v23, v38, v39
    v_lshlrev_b32 v24, 16, v16
    v_and_b32 v25, 0xffff0000, v16
    v_lshlrev_b32 v26, 16, v17
    v_and_b32 v27, 0xffff0000, v17
    v_lshlrev_b32 v28, 16, v18
    v_and_b32 v29, 0xffff0000, v18
    v_lshlrev_b32 v30, 16, v19
    v_and_b32 v31, 0xffff0000, v19
    v_lshlrev_b32 v32, 16, v20
    v_and_b32 v33, 0xffff0000, v20
    v_lshlrev_b32 v34, 16, v21
    v_and_b32 v35, 0xffff0000, v21
    v_lshlrev_b32 v36, 16, v22
    v_and_b32 v37, 0xffff0000, v22
    v_lshlrev_b32 v38, 16, v23
    v_and_b32 v39, 0xffff0000, v23
    v_mul_f32 v24, v24, v124
    v_mul_f32 v25, v25, v124
    v_mul_f32 v26, v26, v124
    v_mul_f32 v27, v27, v124
    v_mul_f32 v28, v28, v124
    v_mul_f32 v29, v29, v124
    v_mul_f32 v30, v30, v124
    v_mul_f32 v31, v31, v124
    v_mul_f32 v32, v32, v124
    v_mul_f32 v33, v33, v124
    v_mul_f32 v34, v34, v124
    v_mul_f32 v35, v35, v124
    v_mul_f32 v36, v36, v124
    v_mul_f32 v37, v37, v124
    v_mul_f32 v38, v38, v124
    v_mul_f32 v39, v39, v124
    v_cvt_pk_bf16_f32 v16, v24, v25
    v_cvt_pk_bf16_f32 v17, v26, v27
    v_cvt_pk_bf16_f32 v18, v28, v29
    v_cvt_pk_bf16_f32 v19, v30, v31
    v_cvt_pk_bf16_f32 v20, v32, v33
    v_cvt_pk_bf16_f32 v21, v34, v35
    v_cvt_pk_bf16_f32 v22, v36, v37
    v_cvt_pk_bf16_f32 v23, v38, v39
    v_perm_b32 v24, v52, v48, s53
    v_perm_b32 v25, v60, v56, s53
    v_perm_b32 v26, v68, v64, s53
    v_perm_b32 v27, v76, v72, s53
    v_perm_b32 v28, v52, v48, s54
    v_perm_b32 v29, v60, v56, s54
    v_perm_b32 v30, v68, v64, s54
    v_perm_b32 v31, v76, v72, s54
    v_mfma_f32_16x16x32_bf16 v[132:135], v[16:19], v[24:27], 0
    v_perm_b32 v32, v53, v49, s53
    v_perm_b32 v33, v61, v57, s53
    v_perm_b32 v34, v69, v65, s53
    v_perm_b32 v35, v77, v73, s53
    v_mfma_f32_16x16x32_bf16 v[136:139], v[16:19], v[28:31], 0
    v_perm_b32 v36, v53, v49, s54
    v_perm_b32 v37, v61, v57, s54
    v_perm_b32 v38, v69, v65, s54
    v_perm_b32 v39, v77, v73, s54
    v_mfma_f32_16x16x32_bf16 v[140:143], v[16:19], v[32:35], 0
    v_perm_b32 v24, v54, v50, s53
    v_perm_b32 v25, v62, v58, s53
    v_perm_b32 v26, v70, v66, s53
    v_perm_b32 v27, v78, v74, s53
    v_mfma_f32_16x16x32_bf16 v[144:147], v[16:19], v[36:39], 0
    v_perm_b32 v28, v54, v50, s54
    v_perm_b32 v29, v62, v58, s54
    v_perm_b32 v30, v70, v66, s54
    v_perm_b32 v31, v78, v74, s54
    v_mfma_f32_16x16x32_bf16 v[148:151], v[16:19], v[24:27], 0
    v_perm_b32 v32, v55, v51, s53
    v_perm_b32 v33, v63, v59, s53
    v_perm_b32 v34, v71, v67, s53
    v_perm_b32 v35, v79, v75, s53
    v_mfma_f32_16x16x32_bf16 v[152:155], v[16:19], v[28:31], 0
    v_perm_b32 v36, v55, v51, s54
    v_perm_b32 v37, v63, v59, s54
    v_perm_b32 v38, v71, v67, s54
    v_perm_b32 v39, v79, v75, s54
    v_mfma_f32_16x16x32_bf16 v[156:159], v[16:19], v[32:35], 0
    s_nop 0
    v_mfma_f32_16x16x32_bf16 v[160:163], v[16:19], v[36:39], 0
    v_perm_b32 v24, v84, v80, s53
    v_perm_b32 v25, v92, v88, s53
    v_perm_b32 v26, v100, v96, s53
    v_perm_b32 v27, v108, v104, s53
    v_perm_b32 v28, v84, v80, s54
    v_perm_b32 v29, v92, v88, s54
    v_perm_b32 v30, v100, v96, s54
    v_perm_b32 v31, v108, v104, s54
    v_mfma_f32_16x16x32_bf16 v[132:135], v[20:23], v[24:27], v[132:135]
    v_perm_b32 v32, v85, v81, s53
    v_perm_b32 v33, v93, v89, s53
    v_perm_b32 v34, v101, v97, s53
    v_perm_b32 v35, v109, v105, s53
    v_mfma_f32_16x16x32_bf16 v[136:139], v[20:23], v[28:31], v[136:139]
    v_perm_b32 v36, v85, v81, s54
    v_perm_b32 v37, v93, v89, s54
    v_perm_b32 v38, v101, v97, s54
    v_perm_b32 v39, v109, v105, s54
    v_mfma_f32_16x16x32_bf16 v[140:143], v[20:23], v[32:35], v[140:143]
    v_perm_b32 v24, v86, v82, s53
    v_perm_b32 v25, v94, v90, s53
    v_perm_b32 v26, v102, v98, s53
    v_perm_b32 v27, v110, v106, s53
    v_mfma_f32_16x16x32_bf16 v[144:147], v[20:23], v[36:39], v[144:147]
    v_perm_b32 v28, v86, v82, s54
    v_perm_b32 v29, v94, v90, s54
    v_perm_b32 v30, v102, v98, s54
    v_perm_b32 v31, v110, v106, s54
    v_mfma_f32_16x16x32_bf16 v[148:151], v[20:23], v[24:27], v[148:151]
    v_perm_b32 v32, v87, v83, s53
    v_perm_b32 v33, v95, v91, s53
    v_perm_b32 v34, v103, v99, s53
    v_perm_b32 v35, v111, v107, s53
    v_mfma_f32_16x16x32_bf16 v[152:155], v[20:23], v[28:31], v[152:155]
    v_perm_b32 v36, v87, v83, s54
    v_perm_b32 v37, v95, v91, s54
    v_perm_b32 v38, v103, v99, s54
    v_perm_b32 v39, v111, v107, s54
    v_mfma_f32_16x16x32_bf16 v[156:159], v[20:23], v[32:35], v[156:159]
    s_nop 0
    v_mfma_f32_16x16x32_bf16 v[160:163], v[20:23], v[36:39], v[160:163]
    s_nop 0
    v_add_f32_dpp v48, v133, v132 row_ror:8 row_mask:0xf bank_mask:0x3
    v_add_f32_dpp v49, v137, v136 row_ror:8 row_mask:0xf bank_mask:0x3
    v_add_f32_dpp v50, v141, v140 row_ror:8 row_mask:0xf bank_mask:0x3
    v_add_f32_dpp v51, v145, v144 row_ror:8 row_mask:0xf bank_mask:0x3
    v_add_f32_dpp v52, v149, v148 row_ror:8 row_mask:0xf bank_mask:0x3
    v_add_f32_dpp v53, v153, v152 row_ror:8 row_mask:0xf bank_mask:0x3
    v_add_f32_dpp v54, v157, v156 row_ror:8 row_mask:0xf bank_mask:0x3
    v_add_f32_dpp v55, v161, v160 row_ror:8 row_mask:0xf bank_mask:0x3
    v_add_f32_dpp v48, v134, v135 row_ror:8 row_mask:0xf bank_mask:0xc
    v_add_f32_dpp v49, v138, v139 row_ror:8 row_mask:0xf bank_mask:0xc
    v_add_f32_dpp v50, v142, v143 row_ror:8 row_mask:0xf bank_mask:0xc
    v_add_f32_dpp v51, v146, v147 row_ror:8 row_mask:0xf bank_mask:0xc
    v_add_f32_dpp v52, v150, v151 row_ror:8 row_mask:0xf bank_mask:0xc
    v_add_f32_dpp v53, v154, v155 row_ror:8 row_mask:0xf bank_mask:0xc
    v_add_f32_dpp v54, v158, v159 row_ror:8 row_mask:0xf bank_mask:0xc
    v_add_f32_dpp v55, v162, v163 row_ror:8 row_mask:0xf bank_mask:0xc
    v_bfi_b32 v48, 15, s96, v48
    v_bfi_b32 v49, 15, s97, v49
    v_bfi_b32 v50, 15, s98, v50
    v_bfi_b32 v51, 15, s99, v51
    v_bfi_b32 v52, 15, s96, v52
    v_bfi_b32 v53, 15, s97, v53
    v_bfi_b32 v54, 15, s98, v54
    v_bfi_b32 v55, 15, s99, v55
    s_waitcnt vmcnt(0)
    buffer_store_dwordx4 v[48:51], v8, s[24:27], s57 offen
    buffer_store_dwordx4 v[52:55], v8, s[24:27], s57 offen offset:128
    v_mov_b32 v13, 0
    s_mov_b32 s55, 0
Ls_1:
    ds_read_b32 v12, v13 offset:1308
    s_waitcnt lgkmcnt(0)
    v_cmp_eq_u32 vcc, -1, v12
    s_cbranch_vccnz Lc_3
Lsok_2:
    s_mov_b32 s47, 0
    s_mov_b32 s55, 0
L_q:
    s_add_u32 s59, s51, 4096
    buffer_load_dwordx4 v[56:59], v4, s[24:27], s51 offen offset:0 sc1
    buffer_load_dwordx4 v[60:63], v4, s[24:27], s51 offen offset:1024 sc1
    buffer_load_dwordx4 v[64:67], v4, s[24:27], s51 offen offset:2048 sc1
    buffer_load_dwordx4 v[68:71], v4, s[24:27], s51 offen offset:3072 sc1
    buffer_load_dwordx4 v[72:75], v4, s[24:27], s59 offen offset:0 sc1
    buffer_load_dwordx4 v[76:79], v4, s[24:27], s59 offen offset:1024 sc1
    buffer_load_dwordx4 v[80:83], v4, s[24:27], s59 offen offset:2048 sc1
    buffer_load_dwordx4 v[84:87], v4, s[24:27], s59 offen offset:3072 sc1
    s_waitcnt vmcnt(0)
    v_xor_b32 v56, s96, v56
    v_xor_b32 v57, s97, v57
    v_xor_b32 v58, s98, v58
    v_xor_b32 v59, s99, v59
    v_xor_b32 v60, s96, v60
    v_xor_b32 v61, s97, v61
    v_xor_b32 v62, s98, v62
    v_xor_b32 v63, s99, v63
    v_xor_b32 v64, s96, v64
    v_xor_b32 v65, s97, v65
    v_xor_b32 v66, s98, v66
    v_xor_b32 v67, s99, v67
    v_xor_b32 v68, s96, v68
    v_xor_b32 v69, s97, v69
    v_xor_b32 v70, s98, v70
    v_xor_b32 v71, s99, v71
    v_xor_b32 v72, s96, v72
    v_xor_b32 v73, s97, v73
    v_xor_b32 v74, s98, v74
    v_xor_b32 v75, s99, v75
    v_xor_b32 v76, s96, v76
    v_xor_b32 v77, s97, v77
    v_xor_b32 v78, s98, v78
    v_xor_b32 v79, s99, v79
    v_xor_b32 v80, s96, v80
    v_xor_b32 v81, s97, v81
    v_xor_b32 v82, s98, v82
    v_xor_b32 v83, s99, v83
    v_xor_b32 v84, s96, v84
    v_xor_b32 v85, s97, v85
    v_xor_b32 v86, s98, v86
    v_xor_b32 v87, s99, v87
    v_or3_b32 v12, v56, v57, v58
    v_or3_b32 v12, v12, v59, v60
    v_or3_b32 v12, v12, v61, v62
    v_or3_b32 v12, v12, v63, v64
    v_or3_b32 v12, v12, v65, v66
    v_or3_b32 v12, v12, v67, v68
    v_or3_b32 v12, v12, v69, v70
    v_or3_b32 v12, v12, v71, v72
    v_or3_b32 v12, v12, v73, v74
    v_or3_b32 v12, v12, v75, v76
    v_or3_b32 v12, v12, v77, v78
    v_or3_b32 v12, v12, v79, v80
    v_or3_b32 v12, v12, v81, v82
    v_or3_b32 v12, v12, v83, v84
    v_or3_b32 v12, v12, v85, v86
    v_or_b32 v12, v12, v87
    v_and_b32 v12, 15, v12
    v_cmp_ne_u32 vcc, 0, v12
    s_cbranch_vccz L_q_ok
    s_add_u32 s55, s55, 1
    s_cmp_lt_u32 s55, 24
    s_cbranch_scc1 L_q
    s_cmp_gt_u32 s55, 24
    s_cbranch_scc1 L_q_tog
    buffer_wbl2 sc1
    v_xor_b32 v51, s52, v51
    v_xor_b32 v55, s52, v55
    s_xor_b32 s57, s57, 3670016
    s_waitcnt vmcnt(0)
    buffer_store_dwordx4 v[48:51], v8, s[24:27], s57 offen sc1
    buffer_store_dwordx4 v[52:55], v8, s[24:27], s57 offen offset:128 sc1
L_q_tog:
    s_xor_b32 s51, s51, 3670016
    s_xor_b32 s99, s99, s52
    s_xor_b32 s47, s47, 1
    s_cmp_lt_u32 s55, 1000000
    s_cbranch_scc1 L_q
L_q_ok:
    s_lshl_b32 s60, s47, 16
    s_or_b32 s60, s60, s29
    v_mov_b32 v12, s60
    v_mov_b32 v13, s28
    v_mov_b32 v15, 0
    ds_write_b64 v15, v[12:13] offset:1280
    v_lshlrev_b32 v10, 4, v9
    v_lshl_add_u32 v10, v3, 7, v10
    v_and_b32 v14, 8, v1
    v_add_u32 v10, v10, v14
    v_pk_add_f32 v[56:57], v[56:57], v[64:65]
    v_pk_add_f32 v[72:73], v[72:73], v[80:81]
    v_pk_add_f32 v[58:59], v[58:59], v[66:67]
    v_pk_add_f32 v[74:75], v[74:75], v[82:83]
    v_pk_add_f32 v[60:61], v[60:61], v[68:69]
    v_pk_add_f32 v[76:77], v[76:77], v[84:85]
    v_pk_add_f32 v[62:63], v[62:63], v[70:71]
    v_pk_add_f32 v[78:79], v[78:79], v[86:87]
    v_pk_add_f32 v[56:57], v[56:57], v[72:73]
    v_pk_add_f32 v[58:59], v[58:59], v[74:75]
    v_pk_add_f32 v[60:61], v[60:61], v[76:77]
    v_pk_add_f32 v[62:63], v[62:63], v[78:79]
    v_cvt_pk_bf16_f32 v24, v56, v57
    v_cvt_pk_bf16_f32 v25, v58, v59
    v_cvt_pk_bf16_f32 v26, v60, v61
    v_cvt_pk_bf16_f32 v27, v62, v63
    v_min_u32 v24, -2, v24
    v_min_u32 v25, -2, v25
    v_min_u32 v26, -2, v26
    v_min_u32 v27, -2, v27
    ds_write_b64 v10, v[24:25] offset:0
    ds_write_b64 v10, v[26:27] offset:512
    s_mov_b64 exec, 0xff
    buffer_load_dwordx4 v[116:119], v4, s[24:27], s50 offen
    s_mov_b64 exec, -1
    v_lshlrev_b32 v14, 3, v3
    s_mov_b32 s55, 0
Ls_4:
    ds_read_b64 v[48:49], v14 offset:1024
    ds_read_b64 v[50:51], v14 offset:1056
    ds_read_b64 v[52:53], v14 offset:1088
    ds_read_b64 v[54:55], v14 offset:1120
    ds_read_b64 v[56:57], v14 offset:1152
    ds_read_b64 v[58:59], v14 offset:1184
    ds_read_b64 v[60:61], v14 offset:1216
    ds_read_b64 v[62:63], v14 offset:1248
    s_waitcnt lgkmcnt(0)
    v_max3_u32 v13, v48, v49, v50
    v_max3_u32 v13, v13, v51, v52
    v_max3_u32 v13, v13, v53, v54
    v_max3_u32 v13, v13, v55, v56
    v_max3_u32 v13, v13, v57, v58
    v_max3_u32 v13, v13, v59, v60
    v_max3_u32 v13, v13, v61, v62
    v_max_u32 v13, v13, v63
    v_cmp_eq_u32 vcc, -1, v13
    s_cbranch_vccnz Lc_6
Lsok_5:
    v_max3_f32 v12, v48, v50, v52
    v_max3_f32 v12, v12, v54, v56
    v_max3_f32 v12, v12, v58, v60
    v_max_f32 v12, v12, v62
    v_sub_f32 v64, v48, v12
    v_sub_f32 v66, v50, v12
    v_sub_f32 v68, v52, v12
    v_sub_f32 v70, v54, v12
    v_sub_f32 v72, v56, v12
    v_sub_f32 v74, v58, v12
    v_sub_f32 v76, v60, v12
    v_sub_f32 v78, v62, v12
    v_mul_f32 v64, 0x3fb8aa3b, v64
    v_mul_f32 v66, 0x3fb8aa3b, v66
    v_mul_f32 v68, 0x3fb8aa3b, v68
    v_mul_f32 v70, 0x3fb8aa3b, v70
    v_mul_f32 v72, 0x3fb8aa3b, v72
    v_mul_f32 v74, 0x3fb8aa3b, v74
    v_mul_f32 v76, 0x3fb8aa3b, v76
    v_mul_f32 v78, 0x3fb8aa3b, v78
    v_exp_f32 v64, v64
    v_exp_f32 v66, v66
    v_exp_f32 v68, v68
    v_exp_f32 v70, v70
    v_exp_f32 v72, v72
    v_exp_f32 v74, v74
    v_exp_f32 v76, v76
    v_exp_f32 v78, v78
    s_nop 0
    v_mul_f32 v13, v64, v49
    v_fmac_f32 v13, v66, v51
    v_fmac_f32 v13, v68, v53
    v_fmac_f32 v13, v70, v55
    v_fmac_f32 v13, v72, v57
    v_fmac_f32 v13, v74, v59
    v_fmac_f32 v13, v76, v61
    v_fmac_f32 v13, v78, v63
    v_min_u32 v12, -2, v12
    v_min_u32 v13, -2, v13
    v_lshl_add_u32 v10, v2, 5, v14
    s_mov_b32 exec_lo, 0x000f000f
    s_mov_b32 exec_hi, 0x000f000f
    s_cmp_lg_u32 s47, 0
    s_cbranch_scc1 L_st_slow
    buffer_store_dwordx2 v[12:13], v10, s[24:27], s50 offen
    s_branch L_st_done
L_st_slow:
    buffer_store_dwordx2 v[12:13], v10, s[24:27], s50 offen sc1
L_st_done:
    s_mov_b64 exec, -1
    v_mul_u32_u24 v10, 544, v3
    v_lshl_add_u32 v10, v2, 5, v10
    s_and_b32 s51, s50, 0xfffffe00
    v_lshlrev_b32 v9, 7, v1
    s_mov_b64 exec, 0xff
    buffer_load_dword v116, v9, s[24:27], s45 offen
    s_mov_b64 exec, -1
    v_lshlrev_b32 v7, 6, v1
    s_lshl_b32 s60, s7, 4
    s_add_u32 s48, s48, s60
    s_and_b32 s60, s49, 7
    s_lshr_b32 s61, s49, 3
    s_lshl_b32 s62, s61, 16
    s_lshl_b32 s63, s4, 11
    s_add_u32 s62, s62, s63
    s_lshl_b32 s63, s60, 8
    s_add_u32 s62, s62, s63
    s_add_u32 s62, s62, 327680
    s_cmp_lt_u32 s7, 2
    s_cselect_b32 s62, s62, 0x80000000
    v_lshrrev_b32 v9, 1, v1
    v_lshlrev_b32 v9, 14, v9
    v_and_b32 v8, 1, v1
    v_lshl_add_u32 v9, v8, 7, v9
    s_mov_b64 exec, 0xff
    buffer_load_dword v115, v9, s[24:27], s62 offen
    v_lshlrev_b32 v9, 7, v1
    s_mov_b64 exec, 15
    buffer_load_dword v114, v9, s[24:27], s46 offen
    s_lshl_b32 s60, s4, 11
    s_lshl_b32 s61, s49, 7
    s_add_u32 s60, s60, s61
    s_add_u32 s60, s60, 1441792
    s_mov_b64 exec, 1
    buffer_load_dword v113, v9, s[24:27], s60 offen
    s_mov_b64 exec, -1
    v_lshl_add_u32 v9, v6, 7, v14
    s_mov_b32 exec_lo, 0x000f000f
    s_mov_b32 exec_hi, 0x000f000f
    buffer_load_dwordx2 v[50:51], v9, s[24:27], s51 offen sc1
    s_mov_b32 s55, 0
L_sx:
    s_waitcnt vmcnt(0)
    v_mov_b32 v48, v50
    v_mov_b32 v49, v51
    v_max_u32 v13, v48, v49
    v_cmp_eq_u32 vcc, -1, v13
    s_cbranch_vccz L_sx_ok
    buffer_load_dwordx2 v[50:51], v9, s[24:27], s51 offen sc1
    s_add_u32 s55, s55, 1
    s_cmp_lt_u32 s55, 1000000
    s_cbranch_scc1 L_sx
L_sx_ok:
    v_mov_b32 v13, v48
    s_nop 1
    v_max_f32_dpp v13, v13, v13 quad_perm:[1,0,3,2] row_mask:0xf bank_mask:0xf
    s_nop 1
    v_max_f32_dpp v13, v13, v13 quad_perm:[2,3,0,1] row_mask:0xf bank_mask:0xf
    v_sub_f32 v48, v48, v13
    v_sub_f32 v12, v12, v13
    v_mul_f32 v48, 0x3fb8aa3b, v48
    v_mul_f32 v12, 0x3fb8aa3b, v12
    v_exp_f32 v48, v48
    v_exp_f32 v12, v12
    v_mul_f32 v13, v48, v49
    s_nop 1
    v_add_f32_dpp v13, v13, v13 quad_perm:[1,0,3,2] row_mask:0xf bank_mask:0xf
    s_nop 1
    v_add_f32_dpp v13, v13, v13 quad_perm:[2,3,0,1] row_mask:0xf bank_mask:0xf
    v_rcp_f32 v13, v13
    s_nop 0
    v_mul_f32 v12, v12, v13
    s_mov_b64 exec, -1
    s_nop 0
    v_mov_b32_dpp v12, v12 row_shr:4 row_mask:0xf bank_mask:0x2
    s_nop 1
    v_mov_b32_dpp v12, v12 row_shr:8 row_mask:0xf bank_mask:0xc
    v_mul_f32 v64, v64, v12
    v_mul_f32 v66, v66, v12
    v_mul_f32 v68, v68, v12
    v_mul_f32 v70, v70, v12
    v_mul_f32 v72, v72, v12
    v_mul_f32 v74, v74, v12
    v_mul_f32 v76, v76, v12
    v_mul_f32 v78, v78, v12
    v_mov_b32 v65, v64
    v_mov_b32 v67, v66
    v_mov_b32 v69, v68
    v_mov_b32 v71, v70
    v_mov_b32 v73, v72
    v_mov_b32 v75, v74
    v_mov_b32 v77, v76
    v_mov_b32 v79, v78
    s_mov_b32 s55, 0
Ls_7:
    ds_read_b128 v[24:27], v15 offset:1312
    s_waitcnt lgkmcnt(0)
    v_max3_u32 v13, v24, v25, v26
    v_max_u32 v13, v13, v27
    v_cmp_eq_u32 vcc, -1, v13
    s_cbranch_vccnz Lc_9
Lsok_8:
    s_mov_b32 s55, 0
Ls_10:
    ds_read_b128 v[24:27], v15 offset:1312
    ds_read_b128 v[112:115], v10 offset:2304
    ds_read_b128 v[116:119], v10 offset:2320
    ds_read_b128 v[120:123], v10 offset:4480
    ds_read_b128 v[124:127], v10 offset:4496
    ds_read_b128 v[128:131], v10 offset:6656
    ds_read_b128 v[132:135], v10 offset:6672
    ds_read_b128 v[136:139], v10 offset:8832
    ds_read_b128 v[140:143], v10 offset:8848
    s_waitcnt lgkmcnt(0)
    v_max3_u32 v13, v24, v25, v26
    v_max_u32 v13, v13, v27
    v_cmp_eq_u32 vcc, -1, v13
    s_cbranch_vccnz Lc_12
Lsok_11:
    v_pk_mul_f32 v[16:17], v[112:113], v[64:65]
    v_pk_mul_f32 v[18:19], v[114:115], v[64:65]
    v_pk_mul_f32 v[20:21], v[116:117], v[64:65]
    v_pk_mul_f32 v[22:23], v[118:119], v[64:65]
    v_pk_fma_f32 v[16:17], v[120:121], v[66:67], v[16:17]
    v_pk_fma_f32 v[18:19], v[122:123], v[66:67], v[18:19]
    v_pk_fma_f32 v[20:21], v[124:125], v[66:67], v[20:21]
    v_pk_fma_f32 v[22:23], v[126:127], v[66:67], v[22:23]
    v_pk_fma_f32 v[16:17], v[128:129], v[68:69], v[16:17]
    v_pk_fma_f32 v[18:19], v[130:131], v[68:69], v[18:19]
    v_pk_fma_f32 v[20:21], v[132:133], v[68:69], v[20:21]
    v_pk_fma_f32 v[22:23], v[134:135], v[68:69], v[22:23]
    v_pk_fma_f32 v[16:17], v[136:137], v[70:71], v[16:17]
    v_pk_fma_f32 v[18:19], v[138:139], v[70:71], v[18:19]
    v_pk_fma_f32 v[20:21], v[140:141], v[70:71], v[20:21]
    v_pk_fma_f32 v[22:23], v[142:143], v[70:71], v[22:23]
    s_mov_b32 s55, 0
Ls_13:
    ds_read_b128 v[24:27], v15 offset:1328
    ds_read_b128 v[112:115], v10 offset:11008
    ds_read_b128 v[116:119], v10 offset:11024
    ds_read_b128 v[120:123], v10 offset:13184
    ds_read_b128 v[124:127], v10 offset:13200
    ds_read_b128 v[128:131], v10 offset:15360
    ds_read_b128 v[132:135], v10 offset:15376
    ds_read_b128 v[136:139], v10 offset:17536
    ds_read_b128 v[140:143], v10 offset:17552
    s_waitcnt lgkmcnt(0)
    v_max3_u32 v13, v24, v25, v26
    v_max_u32 v13, v13, v27
    v_cmp_eq_u32 vcc, -1, v13
    s_cbranch_vccnz Lc_15
Lsok_14:
    v_pk_fma_f32 v[16:17], v[112:113], v[72:73], v[16:17]
    v_pk_fma_f32 v[18:19], v[114:115], v[72:73], v[18:19]
    v_pk_fma_f32 v[20:21], v[116:117], v[72:73], v[20:21]
    v_pk_fma_f32 v[22:23], v[118:119], v[72:73], v[22:23]
    v_pk_fma_f32 v[16:17], v[120:121], v[74:75], v[16:17]
    v_pk_fma_f32 v[18:19], v[122:123], v[74:75], v[18:19]
    v_pk_fma_f32 v[20:21], v[124:125], v[74:75], v[20:21]
    v_pk_fma_f32 v[22:23], v[126:127], v[74:75], v[22:23]
    v_pk_fma_f32 v[16:17], v[128:129], v[76:77], v[16:17]
    v_pk_fma_f32 v[18:19], v[130:131], v[76:77], v[18:19]
    v_pk_fma_f32 v[20:21], v[132:133], v[76:77], v[20:21]
    v_pk_fma_f32 v[22:23], v[134:135], v[76:77], v[22:23]
    v_pk_fma_f32 v[16:17], v[136:137], v[78:79], v[16:17]
    v_pk_fma_f32 v[18:19], v[138:139], v[78:79], v[18:19]
    v_pk_fma_f32 v[20:21], v[140:141], v[78:79], v[20:21]
    v_pk_fma_f32 v[22:23], v[142:143], v[78:79], v[22:23]
    v_cvt_pk_bf16_f32 v112, v16, v17
    v_cvt_pk_bf16_f32 v113, v18, v19
    v_cvt_pk_bf16_f32 v114, v20, v21
    v_cvt_pk_bf16_f32 v115, v22, v23
    v_min_u32 v112, -2, v112
    v_min_u32 v113, -2, v113
    v_min_u32 v114, -2, v114
    v_min_u32 v115, -2, v115
    s_cmp_lg_u32 s47, 0
    s_cbranch_scc1 L_o_slow
    buffer_store_dwordx4 v[112:115], v7, s[24:27], s48 offen
L_o_done:
    ds_write_b32 v15, v15 offset:1304
    s_cmp_lt_u32 s7, 2
    s_cbranch_scc1 L_fin
    s_cmp_eq_u32 s4, 7
    s_cbranch_scc1 L_fin
    s_lshl_b32 s61, s4, 4
    s_add_u32 s61, s61, s49
    s_lshl_b32 s62, s61, 12
    s_add_u32 s62, s62, 917504
    s_lshl_b32 s63, s61, 9
    s_add_u32 s63, s63, 1507328
    s_and_b32 s59, s49, 3
    s_mul_i32 s59, s59, 114688
    s_lshr_b32 s61, s61, 2
    s_lshl_b32 s61, s61, 7
    s_add_u32 s59, s59, s61
    s_add_u32 s59, s59, 458752
    v_lshlrev_b32 v9, 7, v1
    v_mul_u32_u24 v10, 3584, v1
    s_mov_b64 exec, 15
    buffer_load_dword v16, v9, s[24:27], s63 offen
    s_mov_b32 exec_lo, -1
    buffer_load_dword v17, v9, s[24:27], s62 offen
    buffer_load_dword v18, v10, s[24:27], s59 offen
    s_mov_b64 exec, -1
    s_endpgm
L_att2:
    v_lshlrev_b32 v10, 8, v6
    v_lshrrev_b32 v13, 2, v1
    v_lshl_add_u32 v10, v13, 4, v10
    s_mov_b32 s57, 0
    s_load_dwordx2 s[8:9], s[0:1], 72
    s_movk_i32 s10, 8192
    s_cmp_lg_u32 s57, 0
    s_cbranch_scc1 Lcp_16
    ds_read_b128 v[144:147], v10 offset:0
    s_waitcnt lgkmcnt(0)
    v_max3_u32 v13, v144, v145, v146
    v_max_u32 v13, v13, v147
    v_cmp_eq_u32 vcc, -1, v13
    s_cbranch_vccnz Lcp_16
    s_call_b64 s[58:59], L_qks
Lcp_16:
    s_waitcnt vmcnt(4)
    s_add_u32 s63, s101, 20480
    s_and_b32 s63, s63, 0x7000
    s_add_u32 s63, s63, s46
    buffer_load_dwordx4 v[100:103], v4, s[12:15], s63 offen offset:1024 nt
    s_waitcnt vmcnt(4)
    s_add_u32 s63, s101, 24576
    s_and_b32 s63, s63, 0x7000
    s_add_u32 s63, s63, s46
    buffer_load_dwordx4 v[104:107], v4, s[12:15], s63 offen offset:2048 nt
    s_cmp_lg_u32 s57, 0
    s_cbranch_scc1 Lcp_17
    ds_read_b128 v[144:147], v10 offset:0
    s_waitcnt lgkmcnt(0)
    v_max3_u32 v13, v144, v145, v146
    v_max_u32 v13, v13, v147
    v_cmp_eq_u32 vcc, -1, v13
    s_cbranch_vccnz Lcp_17
    s_call_b64 s[58:59], L_qks
Lcp_17:
    s_waitcnt vmcnt(4)
    s_add_u32 s63, s101, 28672
    s_and_b32 s63, s63, 0x7000
    s_add_u32 s63, s63, s46
    buffer_load_dwordx4 v[108:111], v4, s[12:15], s63 offen offset:3072 nt
    s_waitcnt vmcnt(4)
    s_add_u32 s63, s101, 0
    s_and_b32 s63, s63, 0x7000
    s_add_u32 s63, s63, s47
    buffer_load_dwordx4 v[112:115], v4, s[12:15], s63 offen offset:0 nt
    s_cmp_lg_u32 s57, 0
    s_cbranch_scc1 Lcp_18
    ds_read_b128 v[144:147], v10 offset:0
    s_waitcnt lgkmcnt(0)
    v_max3_u32 v13, v144, v145, v146
    v_max_u32 v13, v13, v147
    v_cmp_eq_u32 vcc, -1, v13
    s_cbranch_vccnz Lcp_18
    s_call_b64 s[58:59], L_qks
Lcp_18:
    s_waitcnt vmcnt(4)
    s_add_u32 s63, s101, 4096
    s_and_b32 s63, s63, 0x7000
    s_add_u32 s63, s63, s47
    buffer_load_dwordx4 v[116:119], v4, s[12:15], s63 offen offset:1024 nt
    s_waitcnt vmcnt(4)
    s_add_u32 s63, s101, 8192
    s_and_b32 s63, s63, 0x7000
    s_add_u32 s63, s63, s47
    buffer_load_dwordx4 v[120:123], v4, s[12:15], s63 offen offset:2048 nt
    s_cmp_lg_u32 s57, 0
    s_cbranch_scc1 L_qdone
    s_mov_b32 s55, 0
Ls_19:
    ds_read_b128 v[144:147], v10 offset:0
    s_waitcnt lgkmcnt(0)
    v_max3_u32 v13, v144, v145, v146
    v_max_u32 v13, v13, v147
    v_cmp_eq_u32 vcc, -1, v13
    s_cbranch_vccnz Lc_21
Lsok_20:
    s_call_b64 s[58:59], L_qks
    s_branch L_qdone
L_qks:
    v_mfma_f32_16x16x32_bf16 v[148:151], v[16:19], v[144:147], 0
    v_mfma_f32_16x16x32_bf16 v[16:19], v[20:23], v[144:147], 0
    v_mfma_f32_16x16x32_bf16 v[20:23], v[24:27], v[144:147], 0
    v_mfma_f32_16x16x32_bf16 v[24:27], v[28:31], v[144:147], 0
    v_mfma_f32_16x16x32_bf16 v[28:31], v[32:35], v[144:147], 0
    v_mfma_f32_16x16x32_bf16 v[32:35], v[36:39], v[144:147], 0
    v_mfma_f32_16x16x32_bf16 v[36:39], v[40:43], v[144:147], 0
    v_mfma_f32_16x16x32_bf16 v[40:43], v[44:47], v[144:147], 0
    v_mfma_f32_16x16x32_bf16 v[44:47], v[48:51], v[144:147], 0
    v_mfma_f32_16x16x32_bf16 v[48:51], v[52:55], v[144:147], 0
    v_mfma_f32_16x16x32_bf16 v[52:55], v[56:59], v[144:147], 0
    v_mfma_f32_16x16x32_bf16 v[56:59], v[60:63], v[144:147], 0
    v_mfma_f32_16x16x32_bf16 v[60:63], v[64:67], v[144:147], 0
    v_mfma_f32_16x16x32_bf16 v[64:67], v[68:71], v[144:147], 0
    v_mfma_f32_16x16x32_bf16 v[68:71], v[72:75], v[144:147], 0
    v_mfma_f32_16x16x32_bf16 v[72:75], v[76:79], v[144:147], 0
    v_add_f32_dpp v152, v149, v148 row_ror:12 row_mask:0xf bank_mask:0x1
    v_add_f32_dpp v153, v29, v28 row_ror:12 row_mask:0xf bank_mask:0x1
    v_add_f32_dpp v154, v45, v44 row_ror:12 row_mask:0xf bank_mask:0x1
    s_nop 1
    v_add_f32_dpp v155, v61, v60 row_ror:12 row_mask:0xf bank_mask:0x1
    v_add_f32_dpp v152, v150, v152 row_ror:8 row_mask:0xf bank_mask:0x1
    v_add_f32_dpp v153, v30, v153 row_ror:8 row_mask:0xf bank_mask:0x1
    v_add_f32_dpp v154, v46, v154 row_ror:8 row_mask:0xf bank_mask:0x1
    v_add_f32_dpp v155, v62, v155 row_ror:8 row_mask:0xf bank_mask:0x1
    v_add_f32_dpp v152, v151, v152 row_ror:4 row_mask:0xf bank_mask:0x1
    v_add_f32_dpp v153, v31, v153 row_ror:4 row_mask:0xf bank_mask:0x1
    v_add_f32_dpp v154, v47, v154 row_ror:4 row_mask:0xf bank_mask:0x1
    v_add_f32_dpp v155, v63, v155 row_ror:4 row_mask:0xf bank_mask:0x1
    v_add_f32_dpp v152, v16, v17 row_ror:4 row_mask:0xf bank_mask:0x2
    v_add_f32_dpp v153, v32, v33 row_ror:4 row_mask:0xf bank_mask:0x2
    v_add_f32_dpp v154, v48, v49 row_ror:4 row_mask:0xf bank_mask:0x2
    v_add_f32_dpp v155, v64, v65 row_ror:4 row_mask:0xf bank_mask:0x2
    v_add_f32_dpp v152, v18, v152 row_ror:12 row_mask:0xf bank_mask:0x2
    v_add_f32_dpp v153, v34, v153 row_ror:12 row_mask:0xf bank_mask:0x2
    v_add_f32_dpp v154, v50, v154 row_ror:12 row_mask:0xf bank_mask:0x2
    v_add_f32_dpp v155, v66, v155 row_ror:12 row_mask:0xf bank_mask:0x2
    v_add_f32_dpp v152, v19, v152 row_ror:8 row_mask:0xf bank_mask:0x2
    v_add_f32_dpp v153, v35, v153 row_ror:8 row_mask:0xf bank_mask:0x2
    v_add_f32_dpp v154, v51, v154 row_ror:8 row_mask:0xf bank_mask:0x2
    v_add_f32_dpp v155, v67, v155 row_ror:8 row_mask:0xf bank_mask:0x2
    v_add_f32_dpp v152, v20, v22 row_ror:8 row_mask:0xf bank_mask:0x4
    v_add_f32_dpp v153, v36, v38 row_ror:8 row_mask:0xf bank_mask:0x4
    v_add_f32_dpp v154, v52, v54 row_ror:8 row_mask:0xf bank_mask:0x4
    v_add_f32_dpp v155, v68, v70 row_ror:8 row_mask:0xf bank_mask:0x4
    v_add_f32_dpp v152, v21, v152 row_ror:4 row_mask:0xf bank_mask:0x4
    v_add_f32_dpp v153, v37, v153 row_ror:4 row_mask:0xf bank_mask:0x4
    v_add_f32_dpp v154, v53, v154 row_ror:4 row_mask:0xf bank_mask:0x4
    v_add_f32_dpp v155, v69, v155 row_ror:4 row_mask:0xf bank_mask:0x4
    v_add_f32_dpp v152, v23, v152 row_ror:12 row_mask:0xf bank_mask:0x4
    v_add_f32_dpp v153, v39, v153 row_ror:12 row_mask:0xf bank_mask:0x4
    v_add_f32_dpp v154, v55, v154 row_ror:12 row_mask:0xf bank_mask:0x4
    v_add_f32_dpp v155, v71, v155 row_ror:12 row_mask:0xf bank_mask:0x4
    v_add_f32_dpp v152, v24, v27 row_ror:12 row_mask:0xf bank_mask:0x8
    v_add_f32_dpp v153, v40, v43 row_ror:12 row_mask:0xf bank_mask:0x8
    v_add_f32_dpp v154, v56, v59 row_ror:12 row_mask:0xf bank_mask:0x8
    v_add_f32_dpp v155, v72, v75 row_ror:12 row_mask:0xf bank_mask:0x8
    v_add_f32_dpp v152, v25, v152 row_ror:8 row_mask:0xf bank_mask:0x8
    v_add_f32_dpp v153, v41, v153 row_ror:8 row_mask:0xf bank_mask:0x8
    v_add_f32_dpp v154, v57, v154 row_ror:8 row_mask:0xf bank_mask:0x8
    v_add_f32_dpp v155, v73, v155 row_ror:8 row_mask:0xf bank_mask:0x8
    v_add_f32_dpp v152, v26, v152 row_ror:4 row_mask:0xf bank_mask:0x8
    v_add_f32_dpp v153, v42, v153 row_ror:4 row_mask:0xf bank_mask:0x8
    v_add_f32_dpp v154, v58, v154 row_ror:4 row_mask:0xf bank_mask:0x8
    v_add_f32_dpp v155, v74, v155 row_ror:4 row_mask:0xf bank_mask:0x8
    v_cvt_pk_bf16_f32 v12, v152, v153
    v_cvt_pk_bf16_f32 v13, v154, v155
    v_lshlrev_b32 v152, 16, v12
    v_and_b32 v153, 0xffff0000, v12
    v_lshlrev_b32 v154, 16, v13
    v_and_b32 v155, 0xffff0000, v13
    v_mul_f32 v152, 0x3db504f3, v152
    v_mul_f32 v153, 0x3db504f3, v153
    v_mul_f32 v154, 0x3db504f3, v154
    v_mul_f32 v155, 0x3db504f3, v155
    v_cvt_pk_bf16_f32 v12, v152, v153
    v_cvt_pk_bf16_f32 v13, v154, v155
    v_lshlrev_b32 v152, 16, v12
    v_and_b32 v153, 0xffff0000, v12
    v_lshlrev_b32 v154, 16, v13
    v_and_b32 v155, 0xffff0000, v13
    v_max3_f32 v156, v152, v153, v154
    v_max_f32 v156, v156, v155
    s_nop 1
    v_max_f32_dpp v156, v156, v156 row_ror:4 row_mask:0xf bank_mask:0xf
    s_nop 1
    v_max_f32_dpp v156, v156, v156 row_ror:8 row_mask:0xf bank_mask:0xf
    v_mov_b32 v13, v156
    s_nop 1
    v_permlane16_swap_b32 v156, v13
    s_nop 0
    v_max_f32 v156, v156, v13
    v_mov_b32 v13, v156
    s_nop 1
    v_permlane32_swap_b32 v156, v13
    s_nop 0
    v_max_f32 v156, v156, v13
    v_sub_f32 v152, v152, v156
    v_sub_f32 v153, v153, v156
    v_sub_f32 v154, v154, v156
    v_sub_f32 v155, v155, v156
    v_mul_f32 v152, 0x3fb8aa3b, v152
    v_mul_f32 v153, 0x3fb8aa3b, v153
    v_mul_f32 v154, 0x3fb8aa3b, v154
    v_mul_f32 v155, 0x3fb8aa3b, v155
    v_exp_f32 v152, v152
    v_exp_f32 v153, v153
    v_exp_f32 v154, v154
    v_exp_f32 v155, v155
    s_nop 0
    v_add_f32 v157, v152, v153
    v_add_f32 v13, v154, v155
    v_add_f32 v157, v157, v13
    s_nop 1
    v_add_f32_dpp v157, v157, v157 row_ror:4 row_mask:0xf bank_mask:0xf
    s_nop 1
    v_add_f32_dpp v157, v157, v157 row_ror:8 row_mask:0xf bank_mask:0xf
    v_mov_b32 v13, v157
    s_nop 1
    v_permlane16_swap_b32 v157, v13
    s_nop 0
    v_add_f32 v157, v157, v13
    v_mov_b32 v13, v157
    s_nop 1
    v_permlane32_swap_b32 v157, v13
    s_nop 0
    v_add_f32 v157, v157, v13
    s_lshl_b32 s60, s44, 5
    v_lshl_add_u32 v14, v1, 3, s60
    v_min_u32 v156, -2, v156
    v_min_u32 v157, -2, v157
    s_mov_b64 exec, 15
    ds_write_b64 v14, v[156:157] offset:1024
    s_mov_b64 exec, -1
    v_mov_b32_dpp v48, v152 row_ror:12 row_mask:0xf bank_mask:0xf
    v_mov_b32_dpp v49, v152 row_ror:8 row_mask:0xf bank_mask:0xf
    v_mov_b32_dpp v50, v152 row_ror:4 row_mask:0xf bank_mask:0xf
    v_mov_b32_dpp v51, v153 row_ror:12 row_mask:0xf bank_mask:0xf
    v_mov_b32_dpp v52, v153 row_ror:8 row_mask:0xf bank_mask:0xf
    v_mov_b32_dpp v53, v153 row_ror:4 row_mask:0xf bank_mask:0xf
    v_mov_b32_dpp v54, v154 row_ror:12 row_mask:0xf bank_mask:0xf
    v_mov_b32_dpp v55, v154 row_ror:8 row_mask:0xf bank_mask:0xf
    v_mov_b32_dpp v56, v154 row_ror:4 row_mask:0xf bank_mask:0xf
    v_mov_b32_dpp v57, v155 row_ror:12 row_mask:0xf bank_mask:0xf
    v_mov_b32_dpp v58, v155 row_ror:8 row_mask:0xf bank_mask:0xf
    v_mov_b32_dpp v59, v155 row_ror:4 row_mask:0xf bank_mask:0xf
    v_mov_b32 v16, 0
    v_mov_b32 v17, 0
    v_mov_b32 v18, 0
    v_mov_b32 v19, 0
    v_mov_b32 v32, 0
    v_mov_b32 v33, 0
    v_mov_b32 v34, 0
    v_mov_b32 v35, 0
    s_mov_b32 exec_lo, 0x000f000f
    s_mov_b32 exec_hi, 0x000f000f
    v_cvt_pk_bf16_f32 v16, v152, v48
    v_cvt_pk_bf16_f32 v17, v49, v50
    v_cvt_pk_bf16_f32 v18, v153, v51
    v_cvt_pk_bf16_f32 v19, v52, v53
    v_cvt_pk_bf16_f32 v32, v154, v54
    v_cvt_pk_bf16_f32 v33, v55, v56
    v_cvt_pk_bf16_f32 v34, v155, v57
    v_cvt_pk_bf16_f32 v35, v58, v59
    s_mov_b64 exec, -1
    v_mov_b32_dpp v20, v16 row_shr:4 row_mask:0xf bank_mask:0xf bound_ctrl:1
    v_mov_b32_dpp v21, v17 row_shr:4 row_mask:0xf bank_mask:0xf bound_ctrl:1
    v_mov_b32_dpp v22, v18 row_shr:4 row_mask:0xf bank_mask:0xf bound_ctrl:1
    v_mov_b32_dpp v23, v19 row_shr:4 row_mask:0xf bank_mask:0xf bound_ctrl:1
    v_mov_b32_dpp v24, v16 row_shr:8 row_mask:0xf bank_mask:0xf bound_ctrl:1
    v_mov_b32_dpp v25, v17 row_shr:8 row_mask:0xf bank_mask:0xf bound_ctrl:1
    v_mov_b32_dpp v26, v18 row_shr:8 row_mask:0xf bank_mask:0xf bound_ctrl:1
    v_mov_b32_dpp v27, v19 row_shr:8 row_mask:0xf bank_mask:0xf bound_ctrl:1
    v_mov_b32_dpp v28, v16 row_shr:12 row_mask:0xf bank_mask:0xf bound_ctrl:1
    v_mov_b32_dpp v29, v17 row_shr:12 row_mask:0xf bank_mask:0xf bound_ctrl:1
    v_mov_b32_dpp v30, v18 row_shr:12 row_mask:0xf bank_mask:0xf bound_ctrl:1
    v_mov_b32_dpp v31, v19 row_shr:12 row_mask:0xf bank_mask:0xf bound_ctrl:1
    v_mov_b32_dpp v36, v32 row_shr:4 row_mask:0xf bank_mask:0xf bound_ctrl:1
    v_mov_b32_dpp v37, v33 row_shr:4 row_mask:0xf bank_mask:0xf bound_ctrl:1
    v_mov_b32_dpp v38, v34 row_shr:4 row_mask:0xf bank_mask:0xf bound_ctrl:1
    v_mov_b32_dpp v39, v35 row_shr:4 row_mask:0xf bank_mask:0xf bound_ctrl:1
    v_mov_b32_dpp v40, v32 row_shr:8 row_mask:0xf bank_mask:0xf bound_ctrl:1
    v_mov_b32_dpp v41, v33 row_shr:8 row_mask:0xf bank_mask:0xf bound_ctrl:1
    v_mov_b32_dpp v42, v34 row_shr:8 row_mask:0xf bank_mask:0xf bound_ctrl:1
    v_mov_b32_dpp v43, v35 row_shr:8 row_mask:0xf bank_mask:0xf bound_ctrl:1
    v_mov_b32_dpp v44, v32 row_shr:12 row_mask:0xf bank_mask:0xf bound_ctrl:1
    v_mov_b32_dpp v45, v33 row_shr:12 row_mask:0xf bank_mask:0xf bound_ctrl:1
    v_mov_b32_dpp v46, v34 row_shr:12 row_mask:0xf bank_mask:0xf bound_ctrl:1
    v_mov_b32_dpp v47, v35 row_shr:12 row_mask:0xf bank_mask:0xf bound_ctrl:1
    s_mov_b32 s57, 1
    s_setpc_b64 s[58:59]
L_qdone:
    s_waitcnt vmcnt(4)
    s_add_u32 s63, s101, 12288
    s_and_b32 s63, s63, 0x7000
    s_add_u32 s63, s63, s47
    buffer_load_dwordx4 v[124:127], v4, s[12:15], s63 offen offset:3072 nt
    s_waitcnt vmcnt(4)
    v_perm_b32 v48, v84, v80, s53
    v_perm_b32 v49, v92, v88, s53
    v_perm_b32 v50, v100, v96, s53
    v_perm_b32 v51, v108, v104, s53
    v_perm_b32 v52, v86, v82, s53
    v_perm_b32 v53, v94, v90, s53
    v_perm_b32 v54, v102, v98, s53
    v_perm_b32 v55, v110, v106, s53
    v_mfma_f32_16x16x32_bf16 v[144:147], v[48:51], v[16:19], 0
    v_perm_b32 v56, v84, v80, s54
    v_perm_b32 v57, v92, v88, s54
    v_perm_b32 v58, v100, v96, s54
    v_perm_b32 v59, v108, v104, s54
    v_mfma_f32_16x16x32_bf16 v[148:151], v[52:55], v[16:19], 0
    v_perm_b32 v60, v86, v82, s54
    v_perm_b32 v61, v94, v90, s54
    v_perm_b32 v62, v102, v98, s54
    v_perm_b32 v63, v110, v106, s54
    v_mfma_f32_16x16x32_bf16 v[144:147], v[56:59], v[20:23], v[144:147]
    v_perm_b32 v48, v85, v81, s53
    v_perm_b32 v49, v93, v89, s53
    v_perm_b32 v50, v101, v97, s53
    v_perm_b32 v51, v109, v105, s53
    v_mfma_f32_16x16x32_bf16 v[148:151], v[60:63], v[20:23], v[148:151]
    v_perm_b32 v52, v87, v83, s53
    v_perm_b32 v53, v95, v91, s53
    v_perm_b32 v54, v103, v99, s53
    v_perm_b32 v55, v111, v107, s53
    v_mfma_f32_16x16x32_bf16 v[144:147], v[48:51], v[24:27], v[144:147]
    v_perm_b32 v56, v85, v81, s54
    v_perm_b32 v57, v93, v89, s54
    v_perm_b32 v58, v101, v97, s54
    v_perm_b32 v59, v109, v105, s54
    v_mfma_f32_16x16x32_bf16 v[148:151], v[52:55], v[24:27], v[148:151]
    v_perm_b32 v60, v87, v83, s54
    v_perm_b32 v61, v95, v91, s54
    v_perm_b32 v62, v103, v99, s54
    v_perm_b32 v63, v111, v107, s54
    v_mfma_f32_16x16x32_bf16 v[144:147], v[56:59], v[28:31], v[144:147]
    s_nop 0
    v_mfma_f32_16x16x32_bf16 v[148:151], v[60:63], v[28:31], v[148:151]
    s_add_u32 s63, s101, 16384
    s_and_b32 s63, s63, 0x7000
    s_add_u32 s63, s63, s48
    buffer_load_dwordx4 v[128:131], v4, s[12:15], s63 offen offset:0 nt
    s_add_u32 s63, s101, 20480
    s_and_b32 s63, s63, 0x7000
    s_add_u32 s63, s63, s48
    buffer_load_dwordx4 v[132:135], v4, s[12:15], s63 offen offset:1024 nt
    s_waitcnt vmcnt(5)
    s_add_u32 s63, s101, 24576
    s_and_b32 s63, s63, 0x7000
    s_add_u32 s63, s63, s48
    buffer_load_dwordx4 v[136:139], v4, s[12:15], s63 offen offset:2048 nt
    s_waitcnt vmcnt(5)
    s_add_u32 s63, s101, 28672
    s_and_b32 s63, s63, 0x7000
    s_add_u32 s63, s63, s48
    buffer_load_dwordx4 v[140:143], v4, s[12:15], s63 offen offset:3072 nt
    v_mov_b32 v15, 0
    v_mov_b32 v13, 1
    s_mov_b64 exec, 1
    ds_add_rtn_u32 v5, v15, v13 offset:1296
    s_mov_b64 exec, -1
    ds_read_b64 v[8:9], v15 offset:1280
    s_mul_i32 s60, s44, 2176
    v_mul_u32_u24 v14, 544, v6
    v_lshl_add_u32 v14, v3, 7, v14
    v_and_b32 v12, 48, v11
    v_add3_u32 v14, s60, v14, v12
    s_lshl_b32 s60, s44, 2
    v_mov_b32 v10, s60
    v_lshrrev_b32 v12, 3, v1
    v_and_b32 v13, 7, v1
    v_lshlrev_b32 v7, 10, v3
    v_lshl_add_u32 v7, v2, 4, v7
    s_waitcnt lgkmcnt(0)
    v_readfirstlane_b32 s29, v8
    v_readfirstlane_b32 s28, v9
    v_readfirstlane_b32 s31, v5
    s_and_b32 s96, s29, 15
    s_bfe_u32 s97, s29, 0x40004
    s_bfe_u32 s98, s29, 0x40008
    s_bfe_u32 s99, s29, 0x4000c
    v_perm_b32 v80, v116, v112, s53
    v_perm_b32 v96, v118, v114, s53
    v_perm_b32 v84, v116, v112, s54
    v_perm_b32 v100, v118, v114, s54
    v_perm_b32 v88, v117, v113, s53
    v_perm_b32 v104, v119, v115, s53
    v_perm_b32 v92, v117, v113, s54
    v_perm_b32 v108, v119, v115, s54
    s_waitcnt vmcnt(4)
    v_perm_b32 v81, v124, v120, s53
    v_perm_b32 v97, v126, v122, s53
    v_perm_b32 v85, v124, v120, s54
    v_perm_b32 v101, v126, v122, s54
    v_perm_b32 v89, v125, v121, s53
    v_perm_b32 v105, v127, v123, s53
    v_perm_b32 v93, v125, v121, s54
    v_perm_b32 v109, v127, v123, s54
    s_waitcnt vmcnt(2)
    v_perm_b32 v82, v132, v128, s53
    v_perm_b32 v98, v134, v130, s53
    v_perm_b32 v86, v132, v128, s54
    v_perm_b32 v102, v134, v130, s54
    v_perm_b32 v90, v133, v129, s53
    v_perm_b32 v106, v135, v131, s53
    v_perm_b32 v94, v133, v129, s54
    v_perm_b32 v110, v135, v131, s54
    s_waitcnt vmcnt(0)
    v_perm_b32 v83, v140, v136, s53
    v_perm_b32 v99, v142, v138, s53
    v_perm_b32 v87, v140, v136, s54
    v_perm_b32 v103, v142, v138, s54
    v_perm_b32 v91, v141, v137, s53
    v_perm_b32 v107, v143, v139, s53
    v_perm_b32 v95, v141, v137, s54
    v_perm_b32 v111, v143, v139, s54
    v_mfma_f32_16x16x32_bf16 v[144:147], v[80:83], v[32:35], v[144:147]
    v_mfma_f32_16x16x32_bf16 v[148:151], v[96:99], v[32:35], v[148:151]
    v_mfma_f32_16x16x32_bf16 v[144:147], v[84:87], v[36:39], v[144:147]
    v_mfma_f32_16x16x32_bf16 v[148:151], v[100:103], v[36:39], v[148:151]
    v_mfma_f32_16x16x32_bf16 v[144:147], v[88:91], v[40:43], v[144:147]
    v_mfma_f32_16x16x32_bf16 v[148:151], v[104:107], v[40:43], v[148:151]
    v_mfma_f32_16x16x32_bf16 v[144:147], v[92:95], v[44:47], v[144:147]
    v_mfma_f32_16x16x32_bf16 v[148:151], v[108:111], v[44:47], v[148:151]
    s_nop 6
    ds_write_b128 v14, v[144:147] offset:2304
    ds_write_b128 v14, v[148:151] offset:2368
    s_mov_b64 exec, 1
    ds_write_b32 v10, v15 offset:1312
    s_mov_b64 exec, -1
    s_cmp_ge_u32 s7, 2
    s_cbranch_scc1 L_pathF
    s_and_b32 s60, s49, 7
    s_lshl_b32 s60, s60, 7
    s_add_u32 s52, s52, s60
    s_mov_b32 s55, 0
Lvc_22:
    ds_read_b32 v14, v15 offset:1296
    s_add_u32 s55, s55, 1
    s_waitcnt lgkmcnt(0)
    v_cmp_gt_i32 vcc, 7, v14
    s_cbranch_vccz Lvcok_23
    s_sleep 1
    s_cmp_lt_u32 s55, 40000000
    s_cbranch_scc1 Lvc_22
Lvcok_23:
    s_add_u32 m0, s100, 0
    s_add_u32 s60, s52, 0
    buffer_load_dwordx4 v167, s[20:23], s60 offen nt lds
    s_add_u32 m0, s100, 1056
    s_add_u32 s60, s52, 8192
    buffer_load_dwordx4 v167, s[20:23], s60 offen nt lds
    s_add_u32 m0, s100, 2112
    s_add_u32 s60, s52, 16384
    buffer_load_dwordx4 v167, s[20:23], s60 offen nt lds
    s_add_u32 m0, s100, 3168
    s_add_u32 s60, s52, 24576
    buffer_load_dwordx4 v167, s[20:23], s60 offen nt lds
    s_add_u32 m0, s100, 4224
    s_add_u32 s60, s52, 32768
    buffer_load_dwordx4 v167, s[20:23], s60 offen nt lds
    s_add_u32 m0, s100, 5280
    s_add_u32 s60, s52, 40960
    buffer_load_dwordx4 v167, s[20:23], s60 offen nt lds
    s_add_u32 m0, s100, 6336
    s_add_u32 s60, s52, 49152
    buffer_load_dwordx4 v167, s[20:23], s60 offen nt lds
    s_add_u32 m0, s100, 7392
    s_add_u32 s60, s52, 57344
    buffer_load_dwordx4 v167, s[20:23], s60 offen nt lds
    s_and_b32 s60, s49, 7
    s_lshr_b32 s61, s49, 3
    v_lshrrev_b32 v7, 2, v2
    v_mul_u32_u24 v7, 1056, v7
    v_and_b32 v8, 1, v3
    v_lshl_add_u32 v7, v8, 7, v7
    v_lshrrev_b32 v8, 1, v3
    v_lshl_add_u32 v7, v8, 9, v7
    v_lshl_add_u32 v7, v6, 3, v7
    v_add_u32 v7, s100, v7
    s_lshl_b32 s51, s61, 16
    s_lshl_b32 s63, s4, 11
    s_add_u32 s51, s51, s63
    s_lshl_b32 s63, s60, 8
    s_add_u32 s51, s51, s63
    s_lshl_b32 s63, s44, 14
    s_add_u32 s51, s51, s63
    s_add_u32 s51, s51, 327680
    s_lshl_b32 s61, s61, 2
    s_lshl_b32 s63, s4, 3
    s_add_u32 s61, s61, s63
    s_lshl_b32 s58, s61, 12
    s_lshl_b32 s63, s44, 9
    s_add_u32 s58, s58, s63
    s_add_u32 s58, s58, 65536
    v_lshrrev_b32 v14, 2, v2
    v_lshlrev_b32 v14, 12, v14
    v_lshl_add_u32 v14, v3, 6, v14
    v_lshl_add_u32 v14, v6, 4, v14
    v_lshlrev_b32 v8, 4, v0
    s_lshl_b32 s60, s44, 8
    v_lshlrev_b32 v9, 4, v2
    v_lshl_add_u32 v9, v3, 2, v9
    v_add_u32 v9, s60, v9
    v_lshlrev_b32 v5, 2, v6
    v_lshrrev_b32 v5, v5, s29
    v_and_b32 v5, 15, v5
    s_lshl_b32 s57, s4, 4
    s_add_u32 s57, s57, s49
    s_lshl_b32 s57, s57, 7
    s_add_u32 s57, s57, 128
    s_cmp_eq_u32 s44, 7
    s_cselect_b32 s57, s57, 0x80000000
    s_lshr_b32 s60, s49, 1
    s_and_b32 s61, s49, 1
    s_lshl_b32 s61, s61, 3
    s_add_u32 s61, s61, s44
    s_lshl_b32 s45, s60, 14
    s_lshl_b32 s62, s61, 7
    s_add_u32 s45, s45, s62
    s_add_u32 s45, s45, 327680
    s_lshl_b32 s46, s4, 13
    s_lshl_b32 s62, s61, 9
    s_add_u32 s46, s46, s62
    s_lshl_b32 s62, s60, 4
    s_add_u32 s46, s46, s62
    s_add_u32 s46, s46, 1376256
    s_lshl_b32 s47, s4, 11
    s_lshl_b32 s62, s60, 8
    s_add_u32 s47, s47, s62
    s_lshl_b32 s62, s61, 4
    s_add_u32 s47, s47, s62
    s_add_u32 s47, s47, 1441792
    s_lshl_b32 s48, s60, 10
    s_lshl_b32 s62, s61, 6
    s_add_u32 s48, s48, s62
    v_lshlrev_b32 v12, 11, v12
    v_lshl_add_u32 v12, v13, 4, v12
    v_lshrrev_b32 v10, 5, v1
    v_lshlrev_b32 v10, 2, v10
    v_lshl_add_u32 v97, v13, 3, v10
    v_and_b32 v15, 1, v13
    v_lshl_add_u32 v10, v15, 3, v10
    v_lshrrev_b32 v13, 1, v13
    v_lshl_add_u32 v13, v13, 7, v10
    buffer_load_dword v96, v97, s[16:19], s48 offen
    s_waitcnt vmcnt(5)
    ds_read_b64_tr_b16 v[112:113], v7 offset:0
    ds_read_b64_tr_b16 v[114:115], v7 offset:256
    ds_read_b64_tr_b16 v[116:117], v7 offset:32
    ds_read_b64_tr_b16 v[118:119], v7 offset:288
    ds_read_b64_tr_b16 v[120:121], v7 offset:64
    ds_read_b64_tr_b16 v[122:123], v7 offset:320
    ds_read_b64_tr_b16 v[124:125], v7 offset:96
    ds_read_b64_tr_b16 v[126:127], v7 offset:352
    s_waitcnt lgkmcnt(0)
    s_waitcnt vmcnt(1)
    ds_read_b64_tr_b16 v[128:129], v7 offset:4224
    ds_read_b64_tr_b16 v[130:131], v7 offset:4480
    ds_read_b64_tr_b16 v[132:133], v7 offset:4256
    ds_read_b64_tr_b16 v[134:135], v7 offset:4512
    ds_read_b64_tr_b16 v[136:137], v7 offset:4288
    ds_read_b64_tr_b16 v[138:139], v7 offset:4544
    ds_read_b64_tr_b16 v[140:141], v7 offset:4320
    ds_read_b64_tr_b16 v[142:143], v7 offset:4576
    v_mov_b32 v89, 0
    s_mov_b32 s55, 0
Ls_24:
    ds_read_b32 v88, v89 offset:1304
    s_waitcnt lgkmcnt(0)
    v_cmp_eq_u32 vcc, -1, v88
    s_cbranch_vccnz Lc_26
Lsok_25:
    buffer_load_dwordx4 v[88:91], v14, s[24:27], s58 offen offset:0 sc1
    buffer_load_dwordx4 v[92:95], v14, s[24:27], s58 offen offset:256 sc1
    s_waitcnt lgkmcnt(0)
    s_mov_b32 s55, 0
    s_waitcnt vmcnt(0)
Lretry_27:
    v_max3_u32 v15, v88, v89, v90
    v_max3_u32 v15, v15, v91, v92
    v_max3_u32 v15, v15, v93, v94
    v_max_u32 v15, v15, v95
    v_cmp_eq_u32 vcc, -1, v15
    s_cbranch_vccnz Lc_29
Lok_28:
    v_mfma_f32_16x16x32_bf16 v[16:19], v[88:91], v[112:115], 0
    v_mfma_f32_16x16x32_bf16 v[20:23], v[88:91], v[116:119], 0
    v_mfma_f32_16x16x32_bf16 v[24:27], v[88:91], v[120:123], 0
    v_mfma_f32_16x16x32_bf16 v[28:31], v[88:91], v[124:127], 0
    v_mfma_f32_16x16x32_bf16 v[16:19], v[92:95], v[128:131], v[16:19]
    v_mfma_f32_16x16x32_bf16 v[20:23], v[92:95], v[132:135], v[20:23]
    v_mfma_f32_16x16x32_bf16 v[24:27], v[92:95], v[136:139], v[24:27]
    v_mfma_f32_16x16x32_bf16 v[28:31], v[92:95], v[140:143], v[28:31]
    s_nop 4
    v_pk_add_f32 v[16:17], v[16:17], v[18:19]
    v_pk_add_f32 v[20:21], v[20:21], v[22:23]
    v_pk_add_f32 v[24:25], v[24:25], v[26:27]
    v_pk_add_f32 v[28:29], v[28:29], v[30:31]
    v_add_f32 v32, v16, v17
    v_add_f32 v33, v20, v21
    v_add_f32 v34, v24, v25
    v_add_f32 v35, v28, v29
    ds_write_b128 v8, v[32:35] offset:19712
    s_waitcnt lgkmcnt(0)
    s_barrier
    s_cmp_ge_u32 s44, 4
    s_cbranch_scc1 L_yd
    ds_read2st64_b32 v[32:33], v9 offset0:77 offset1:81
    ds_read2st64_b32 v[34:35], v9 offset0:85 offset1:89
    ds_read2st64_b32 v[36:37], v9 offset0:93 offset1:97
    ds_read2st64_b32 v[38:39], v9 offset0:101 offset1:105
    s_waitcnt lgkmcnt(2)
    v_pk_add_f32 v[32:33], v[32:33], v[34:35]
    s_waitcnt lgkmcnt(0)
    v_pk_add_f32 v[36:37], v[36:37], v[38:39]
    v_pk_add_f32 v[32:33], v[32:33], v[36:37]
    v_add_f32 v32, v32, v33
    v_bfi_b32 v32, 15, v5, v32
    buffer_store_dword v32, v11, s[24:27], s51 offen sc1
L_yd:
    s_cmp_eq_u32 s4, 7
    s_cbranch_scc1 L_fin
    v_lshlrev_b32 v98, 16, v96
    v_and_b32 v99, 0xffff0000, v96
    s_waitcnt vmcnt(0)
    s_barrier
    buffer_load_dwordx4 v[48:51], v12, s[24:27], s45 offen sc1
    s_mov_b32 s55, 0
    s_waitcnt vmcnt(0)
Lt_30:
    v_xor_b32 v48, s96, v48
    v_xor_b32 v49, s97, v49
    v_xor_b32 v50, s98, v50
    v_xor_b32 v51, s99, v51
    v_or3_b32 v15, v48, v49, v50
    v_or_b32 v15, v15, v51
    v_and_b32 v15, 15, v15
    v_cmp_ne_u32 vcc, 0, v15
    s_cbranch_vccnz Lc_32
Ltok_31:
    v_permlane32_swap_b32 v48, v50
    v_permlane32_swap_b32 v49, v51
    s_nop 0
    v_pk_add_f32 v[48:49], v[48:49], v[50:51]
    s_nop 0
    v_mov_b32 v50, v48
    v_mov_b32 v51, v49
    s_nop 0
    v_permlane16_swap_b32 v48, v50
    v_permlane16_swap_b32 v49, v51
    s_nop 0
    v_pk_add_f32 v[48:49], v[48:49], v[50:51]
    s_nop 1
    v_add_f32_dpp v48, v48, v48 row_ror:8 row_mask:0xf bank_mask:0xf
    v_add_f32_dpp v49, v49, v49 row_ror:8 row_mask:0xf bank_mask:0xf
    v_cvt_pk_bf16_f32 v50, v48, v49
    v_lshlrev_b32 v48, 16, v50
    v_and_b32 v49, 0xffff0000, v50
    v_pk_add_f32 v[48:49], v[48:49], v[98:99]
    v_cvt_pk_bf16_f32 v50, v48, v49
    v_min_u32 v51, -2, v50
    s_mov_b32 exec_lo, 0xff
    s_mov_b32 exec_hi, 0xff
    s_bitcmp1_b32 s29, 16
    s_cbranch_scc1 Lsl_33
    buffer_store_dword v51, v13, s[24:27], s46 offen
Lsd_34:
    s_mov_b64 exec, -1
    v_lshlrev_b32 v48, 16, v50
    v_and_b32 v49, 0xffff0000, v50
    v_add_f32 v52, v48, v49
    v_mul_f32 v53, v48, v48
    v_fmac_f32 v53, v49, v49
    s_nop 0
    s_nop 0
    v_add_f32_dpp v52, v52, v52 quad_perm:[1,0,3,2] row_mask:0xf bank_mask:0xf
    v_add_f32_dpp v53, v53, v53 quad_perm:[1,0,3,2] row_mask:0xf bank_mask:0xf
    s_nop 0
    v_add_f32_dpp v52, v52, v52 quad_perm:[2,3,0,1] row_mask:0xf bank_mask:0xf
    v_add_f32_dpp v53, v53, v53 quad_perm:[2,3,0,1] row_mask:0xf bank_mask:0xf
    s_nop 0
    v_add_f32_dpp v52, v52, v52 row_half_mirror row_mask:0xf bank_mask:0xf
    v_add_f32_dpp v53, v53, v53 row_half_mirror row_mask:0xf bank_mask:0xf
    v_mov_b32 v54, v52
    v_mov_b32 v55, v53
    s_nop 0
    v_permlane32_swap_b32 v52, v54
    v_permlane32_swap_b32 v53, v55
    s_nop 0
    v_pk_add_f32 v[52:53], v[52:53], v[54:55]
    v_mov_b32 v54, v53
    v_mov_b32 v53, s28
    v_mov_b32 v55, s28
    s_mov_b64 exec, 1
    s_bitcmp1_b32 s29, 16
    s_cbranch_scc1 Lsl_35
    buffer_store_dwordx4 v[52:55], v4, s[24:27], s47 offen
Lsd_36:
    s_or_b32 s60, s2, s44
    s_cmp_lg_u32 s60, 0
    s_cbranch_scc1 L_noep
    buffer_store_dword v55, v4, s[24:27], 0 offen sc1
L_noep:
    s_mov_b64 exec, -1
    s_endpgm
L_pathF:
    s_mov_b32 s55, 0
Lvc_37:
    ds_read_b32 v14, v15 offset:1296
    s_add_u32 s55, s55, 1
    s_waitcnt lgkmcnt(0)
    v_cmp_gt_i32 vcc, 7, v14
    s_cbranch_vccz Lvcok_38
    s_sleep 1
    s_cmp_lt_u32 s55, 40000000
    s_cbranch_scc1 Lvc_37
Lvcok_38:
    s_lshl_b32 s60, s4, 19
    s_lshl_b32 s61, s49, 15
    s_add_u32 s60, s60, s61
    s_lshl_b32 s61, s44, 12
    s_add_u32 s60, s60, s61
    buffer_load_dwordx4 v[48:51], v4, s[20:23], s60 offen offset:0
    buffer_load_dwordx4 v[52:55], v4, s[20:23], s60 offen offset:1024
    buffer_load_dwordx4 v[56:59], v4, s[20:23], s60 offen offset:2048
    buffer_load_dwordx4 v[60:63], v4, s[20:23], s60 offen offset:3072
L_nopf:
    s_cmp_eq_u32 s4, 7
    s_cbranch_scc1 L_fin
    s_lshr_b32 s51, s49, 2
    s_lshl_b32 s61, s4, 2
    s_add_u32 s51, s51, s61
    s_and_b32 s48, s49, 3
    v_mul_u32_u24 v5, 3584, v12
    v_and_b32 v8, 2, v12
    v_xor_b32 v8, v8, v13
    v_lshl_add_u32 v167, v8, 4, v5
    v_mov_b32 v166, v7
    s_lshl_b32 s12, s48, 3
    s_add_u32 s12, s12, s44
    s_mul_i32 s12, s12, 57344
    s_lshl_b32 s60, s51, 7
    s_add_u32 s12, s12, s60
    s_lshl_b32 s13, s51, 16
    s_lshl_b32 s60, s44, 13
    s_add_u32 s13, s13, s60
    s_lshl_b32 s60, s48, 8
    s_add_u32 s13, s13, s60
    s_mul_i32 s14, s44, 2176
    s_add_u32 s14, s14, 60416
    v_lshrrev_b32 v8, 2, v2
    v_lshlrev_b32 v9, 3, v6
    v_lshl_add_u32 v5, v8, 7, v9
    v_lshl_add_u32 v7, v8, 8, v9
    v_mul_u32_u24 v9, 1088, v3
    v_add_u32 v5, v5, v9
    v_lshl_add_u32 v7, v9, 1, v7
    s_and_b32 s63, s44, 3
    v_lshrrev_b32 v8, 1, v8
    v_xor_b32 v8, s63, v8
    v_lshl_add_u32 v5, v8, 5, v5
    s_lshr_b32 s62, s44, 2
    s_mul_i32 s62, s62, 17408
    s_add_u32 s62, s62, 60416
    v_add_u32 v5, s62, v5
    s_lshl_b32 s62, s44, 5
    s_add_u32 s62, s62, 95232
    v_add_u32 v7, s62, v7
    v_mul_u32_u24 v10, 3584, v12
    v_lshl_add_u32 v10, v13, 4, v10
    v_mul_u32_u24 v9, 144, v13
    v_lshl_add_u32 v9, v3, 4, v9
    v_lshlrev_b32 v14, 7, v3
    v_lshl_add_u32 v14, v13, 4, v14
    s_lshl_b32 s58, s4, 13
    s_lshl_b32 s60, s48, 11
    s_add_u32 s58, s58, s60
    s_add_u32 s58, s58, 1376256
    s_and_b32 s62, s44, 1
    s_lshl_b32 s62, s62, 2
    v_add_u32 v12, s62, v3
    v_mul_u32_u24 v8, 144, v12
    v_lshl_add_u32 v8, v2, 1, v8
    s_lshr_b32 s62, s44, 1
    s_lshl_b32 s63, s62, 5
    v_add_u32 v8, s63, v8
    v_lshlrev_b32 v6, 9, v3
    v_lshl_add_u32 v6, v2, 2, v6
    v_lshlrev_b32 v148, 12, v3
    v_lshl_add_u32 v148, v2, 4, v148
    s_lshl_b32 s46, s51, 14
    s_add_u32 s46, s46, 917504
    s_lshl_b32 s57, s51, 11
    s_add_u32 s57, s57, 1507328
    s_lshl_b32 s63, s44, 6
    s_add_u32 s30, s57, s63
    s_lshl_b32 s63, s44, 8
    s_add_u32 s45, s46, s63
    s_lshl_b32 s62, s48, 3
    s_add_u32 s62, s62, s44
    s_lshl_b32 s47, s62, 9
    s_add_u32 s47, s47, s46
    s_mul_i32 s50, s62, 14336
    s_lshl_b32 s63, s51, 7
    s_add_u32 s50, s50, s63
    s_add_u32 s50, s50, 458752
    s_lshl_b32 s62, s48, 9
    s_add_u32 s57, s30, s62
    s_mul_i32 s63, s44, 28
    s_add_u32 s56, s63, s51
    s_lshl_b32 s63, s48, 5
    s_add_u32 s63, s63, s56
    s_mul_i32 s31, s63, 3584
    s_add_u32 s31, s31, 458752
    s_lshr_b32 s62, s56, 2
    s_lshl_b32 s62, s62, 1
    s_and_b32 s63, s56, 1
    s_add_u32 s62, s62, s63
    s_bfe_u32 s63, s56, 0x10001
    s_lshl_b32 s52, s62, 7
    s_add_u32 s52, s52, s58
    s_lshl_b32 s60, s63, 6
    s_add_u32 s52, s52, s60
    s_lshl_b32 s59, s4, 11
    s_lshl_b32 s60, s63, 10
    s_add_u32 s59, s59, s60
    s_add_u32 s59, s59, 1441792
    s_lshl_b32 s62, s62, 4
    s_lshl_b32 s63, s63, 12
    s_add_u32 s62, s62, s63
    s_lshl_b32 s63, s48, 8
    s_add_u32 s100, s62, s63
    v_lshlrev_b32 v13, 1, v13
    v_lshl_add_u32 v151, v3, 4, v13
    v_lshl_add_u32 v150, v3, 10, v13
    v_and_b32 v149, 12, v11
    v_lshrrev_b32 v149, v149, s29
    v_and_b32 v149, 15, v149
    v_mov_b32 v40, 0x3f803f80
    v_mov_b32 v41, 0x3f803f80
    v_mov_b32 v42, 0x3f803f80
    v_mov_b32 v43, 0x3f803f80
    v_mov_b32 v64, 0
    v_mov_b32 v65, 0
    v_mov_b32 v66, 0
    v_mov_b32 v67, 0
    v_mov_b32 v68, 0
    v_mov_b32 v69, 0
    v_mov_b32 v70, 0
    v_mov_b32 v71, 0
    v_mov_b32 v72, 0
    v_mov_b32 v73, 0
    v_mov_b32 v74, 0
    v_mov_b32 v75, 0
    v_mov_b32 v76, 0
    v_mov_b32 v77, 0
    v_mov_b32 v78, 0
    v_mov_b32 v79, 0
    s_mov_b32 s55, 0
Ls_39:
    ds_read_b32 v16, v15 offset:1304
    s_waitcnt lgkmcnt(0)
    v_cmp_eq_u32 vcc, -1, v16
    s_cbranch_vccnz Lc_41
Lsok_40:
    s_waitcnt vmcnt(0)
    s_add_u32 m0, s14, 0
    s_add_u32 s62, s12, 0
    buffer_load_dwordx4 v167, s[32:35], s62 offen nt lds
    s_add_u32 m0, s14, 1088
    s_add_u32 s62, s12, 28672
    buffer_load_dwordx4 v167, s[32:35], s62 offen nt lds
    s_add_u32 m0, s14, 17408
    s_add_u32 s62, s12, 0
    buffer_load_dwordx4 v167, s[40:43], s62 offen nt lds
    s_add_u32 m0, s14, 18496
    s_add_u32 s62, s12, 28672
    buffer_load_dwordx4 v167, s[40:43], s62 offen nt lds
    s_add_u32 m0, s14, 34816
    s_add_u32 s62, s13, 0
    buffer_load_dwordx4 v166, s[36:39], s62 offen nt lds
    s_add_u32 m0, s14, 35904
    s_add_u32 s62, s13, 4096
    buffer_load_dwordx4 v166, s[36:39], s62 offen nt lds
    s_waitcnt vmcnt(0)
    s_barrier
    ds_read_b64_tr_b16 v[16:17], v5 offset:0
    ds_read_b64_tr_b16 v[18:19], v5 offset:512
    ds_read_b64_tr_b16 v[20:21], v5 offset:4352
    ds_read_b64_tr_b16 v[22:23], v5 offset:4864
    ds_read_b64_tr_b16 v[24:25], v5 offset:8704
    ds_read_b64_tr_b16 v[26:27], v5 offset:9216
    ds_read_b64_tr_b16 v[28:29], v5 offset:13056
    ds_read_b64_tr_b16 v[30:31], v5 offset:13568
    ds_read_b64_tr_b16 v[32:33], v7 offset:0
    ds_read_b64_tr_b16 v[34:35], v7 offset:1088
    ds_read_b64_tr_b16 v[36:37], v7 offset:8704
    ds_read_b64_tr_b16 v[38:39], v7 offset:9792
    s_waitcnt lgkmcnt(4)
    v_mfma_f32_16x16x32_bf16 v[44:47], v[40:43], v[16:19], 0
    v_mfma_f32_16x16x32_bf16 v[44:47], v[40:43], v[20:23], v[44:47]
    v_mfma_f32_16x16x32_bf16 v[44:47], v[40:43], v[24:27], v[44:47]
    v_mfma_f32_16x16x32_bf16 v[44:47], v[40:43], v[28:31], v[44:47]
    s_nop 7
    v_bfi_b32 v44, 15, v149, v44
    s_mov_b64 exec, 0xffff
    s_bitcmp1_b32 s29, 16
    s_cbranch_scc1 Lsl_42
    buffer_store_dword v44, v11, s[24:27], s57 offen
Lsd_43:
    s_mov_b64 exec, -1
    v_and_b32 v81, 8, v1
    v_lshl_add_u32 v14, v81, 7, v14
    s_mov_b32 s55, 0
    s_waitcnt vmcnt(0) lgkmcnt(0)
L_h0:
    buffer_load_dword v80, v6, s[24:27], s30 offen sc1
    buffer_load_dwordx4 v[64:67], v14, s[24:27], s58 offen offset:0 sc1
    buffer_load_dwordx4 v[68:71], v14, s[24:27], s58 offen offset:512 sc1
    s_waitcnt vmcnt(2)
    v_xor_b32 v80, v149, v80
    v_and_b32 v145, 15, v80
    v_cmp_ne_u32 vcc, 0, v145
    s_or_b32 s12, vcc_lo, vcc_hi
    v_mov_b32 v82, v80
    s_nop 1
    v_permlane16_swap_b32 v80, v82
    s_nop 0
    v_add_f32 v80, v80, v82
    v_mov_b32 v82, v80
    s_nop 1
    v_permlane32_swap_b32 v80, v82
    s_nop 0
    v_add_f32 v80, v80, v82
    v_mul_f32 v80, 0xbb000000, v80
    s_waitcnt vmcnt(0)
L_h1:
    v_max3_u32 v145, v64, v65, v66
    v_max3_u32 v145, v145, v67, v68
    v_max3_u32 v145, v145, v69, v70
    v_max_u32 v145, v145, v71
    v_cmp_eq_u32 vcc, -1, v145
    s_cbranch_vccnz L_h2
L_h3:
    v_mfma_f32_16x16x32_bf16 v[152:155], v[64:67], v[40:43], 0
    v_mfma_f32_16x16x32_bf16 v[44:47], v[64:67], v[16:19], 0
    v_mov_b32_dpp v72, v64 row_ror:8 row_mask:0xf bank_mask:0xf
    v_mov_b32_dpp v73, v65 row_ror:8 row_mask:0xf bank_mask:0xf
    v_mov_b32_dpp v74, v66 row_ror:8 row_mask:0xf bank_mask:0xf
    v_mov_b32_dpp v75, v67 row_ror:8 row_mask:0xf bank_mask:0xf
    v_mfma_f32_16x16x32_bf16 v[152:155], v[68:71], v[40:43], v[152:155]
    v_mfma_f32_16x16x32_bf16 v[44:47], v[68:71], v[20:23], v[44:47]
    v_mov_b32_dpp v76, v68 row_ror:8 row_mask:0xf bank_mask:0xf
    v_mov_b32_dpp v77, v69 row_ror:8 row_mask:0xf bank_mask:0xf
    v_mov_b32_dpp v78, v70 row_ror:8 row_mask:0xf bank_mask:0xf
    v_mov_b32_dpp v79, v71 row_ror:8 row_mask:0xf bank_mask:0xf
    v_mfma_f32_16x16x32_bf16 v[152:155], v[72:75], v[40:43], v[152:155]
    v_mfma_f32_16x16x32_bf16 v[44:47], v[72:75], v[24:27], v[44:47]
    v_mfma_f32_16x16x32_bf16 v[152:155], v[76:79], v[40:43], v[152:155]
    v_mfma_f32_16x16x32_bf16 v[44:47], v[76:79], v[28:31], v[44:47]
    s_cmp_lg_u32 s12, 0
    s_cbranch_scc1 L_cs_late
L_cs_ok:
    s_nop 5
    v_fmac_f32 v44, v152, v80
    v_fmac_f32 v45, v153, v80
    v_fmac_f32 v46, v154, v80
    v_fmac_f32 v47, v155, v80
    v_bfi_b32 v44, 15, s96, v44
    v_bfi_b32 v45, 15, s97, v45
    v_bfi_b32 v46, 15, s98, v46
    v_bfi_b32 v47, 15, s99, v47
    s_mov_b32 exec_hi, 0
    s_bitcmp1_b32 s29, 16
    s_cbranch_scc1 Lsl_47
    buffer_store_dwordx4 v[44:47], v4, s[24:27], s47 offen
Lsd_48:
    s_mov_b32 exec_hi, -1
    s_waitcnt vmcnt(0)
    buffer_load_dwordx4 v[88:91], v148, s[24:27], s45 offen offset:0 sc1
    buffer_load_dwordx4 v[92:95], v148, s[24:27], s45 offen offset:2048 sc1
    s_mov_b32 s55, 0
    s_waitcnt vmcnt(0)
Lt_49:
    v_xor_b32 v88, s96, v88
    v_xor_b32 v89, s97, v89
    v_xor_b32 v90, s98, v90
    v_xor_b32 v91, s99, v91
    v_xor_b32 v92, s96, v92
    v_xor_b32 v93, s97, v93
    v_xor_b32 v94, s98, v94
    v_xor_b32 v95, s99, v95
    v_or3_b32 v145, v88, v89, v90
    v_or3_b32 v145, v145, v91, v92
    v_or3_b32 v145, v145, v93, v94
    v_or_b32 v145, v145, v95
    v_and_b32 v145, 15, v145
    v_cmp_ne_u32 vcc, 0, v145
    s_cbranch_vccnz Lc_51
Ltok_50:
    v_permlane32_swap_b32 v88, v90
    v_permlane32_swap_b32 v89, v91
    v_permlane32_swap_b32 v92, v94
    v_permlane32_swap_b32 v93, v95
    s_nop 0
    v_pk_add_f32 v[88:89], v[88:89], v[90:91]
    v_pk_add_f32 v[92:93], v[92:93], v[94:95]
    s_nop 0
    v_permlane16_swap_b32 v88, v89
    v_permlane16_swap_b32 v92, v93
    s_nop 0
    v_add_f32 v88, v88, v89
    v_add_f32 v89, v92, v93
    v_mul_f32 v88, v88, v89
    v_cvt_pk_bf16_f32 v88, v88, v88
    ds_write_b16 v8, v88 offset:30208
    s_waitcnt lgkmcnt(0)
    s_barrier
    ds_read_b128 v[64:67], v9 offset:30208
    ds_read_b128 v[68:71], v9 offset:30272
    s_waitcnt lgkmcnt(1)
    v_mfma_f32_16x16x32_bf16 v[44:47], v[64:67], v[32:35], 0
    s_waitcnt lgkmcnt(0)
    v_mfma_f32_16x16x32_bf16 v[44:47], v[68:71], v[36:39], v[44:47]
    s_nop 7
    v_bfi_b32 v44, 15, s96, v44
    v_bfi_b32 v45, 15, s97, v45
    v_bfi_b32 v46, 15, s98, v46
    v_bfi_b32 v47, 15, s99, v47
    s_mov_b32 exec_hi, 0
    buffer_store_dwordx4 v[44:47], v10, s[24:27], s50 offen sc1
    s_mov_b64 exec, -1
    s_cmp_ge_u32 s56, 32
    s_cbranch_scc1 L_fin
    buffer_load_dwordx4 v[84:87], v4, s[24:27], s59 offen sc1
    buffer_load_ushort v112, v151, s[24:27], s52 offen sc1
    v_mov_b32 v14, 0x80000000
    v_cmp_gt_u32 vcc, 32, v1
    s_nop 1
    v_cndmask_b32 v13, v14, v4, vcc
    s_waitcnt vmcnt(2)
    buffer_load_dwordx4 v[96:99], v4, s[24:27], s31 offen offset:0 sc1
    buffer_load_dwordx4 v[100:103], v4, s[24:27], s31 offen offset:1024 sc1
    buffer_load_dwordx4 v[104:107], v4, s[24:27], s31 offen offset:2048 sc1
    buffer_load_dwordx4 v[108:111], v13, s[24:27], s31 offen offset:3072 sc1
    s_mov_b32 s55, 0
    s_waitcnt vmcnt(4)
L_ln:
    v_cmp_ne_u32 vcc, s28, v85
    v_cmp_ne_u32 s[60:61], s28, v87
    s_or_b64 vcc, vcc, s[60:61]
    s_cbranch_vccz L_ln_ok
    buffer_load_dwordx4 v[84:87], v4, s[24:27], s59 offen sc1
    s_add_u32 s55, s55, 1
    s_cmp_lt_u32 s55, 1000000
    s_waitcnt vmcnt(0)
    s_cbranch_scc1 L_ln
L_ln_ok:
    v_mov_b32 v85, v86
    s_nop 0
    s_nop 0
    v_add_f32_dpp v84, v84, v84 quad_perm:[1,0,3,2] row_mask:0xf bank_mask:0xf
    v_add_f32_dpp v85, v85, v85 quad_perm:[1,0,3,2] row_mask:0xf bank_mask:0xf
    s_nop 0
    v_add_f32_dpp v84, v84, v84 quad_perm:[2,3,0,1] row_mask:0xf bank_mask:0xf
    v_add_f32_dpp v85, v85, v85 quad_perm:[2,3,0,1] row_mask:0xf bank_mask:0xf
    s_nop 0
    v_add_f32_dpp v84, v84, v84 row_half_mirror row_mask:0xf bank_mask:0xf
    v_add_f32_dpp v85, v85, v85 row_half_mirror row_mask:0xf bank_mask:0xf
    s_nop 0
    v_add_f32_dpp v84, v84, v84 row_mirror row_mask:0xf bank_mask:0xf
    v_add_f32_dpp v85, v85, v85 row_mirror row_mask:0xf bank_mask:0xf
    v_mul_f32 v84, 0x3b000000, v84
    v_mul_f32 v85, 0x3b000000, v85
    v_fma_f32 v85, -v84, v84, v85
    v_max_f32 v85, 0, v85
    v_cvt_pk_bf16_f32 v87, v84, v85
    v_lshlrev_b32 v84, 16, v87
    v_and_b32 v85, 0xffff0000, v87
    v_add_f32 v85, 0x3727c5ac, v85
    v_cvt_pk_bf16_f32 v87, v85, v85
    v_lshlrev_b32 v85, 16, v87
    v_sqrt_f32 v85, v85
    s_nop 0
    v_cvt_pk_bf16_f32 v87, v85, v85
    v_lshlrev_b32 v85, 16, v87
    v_rcp_f32 v85, v85
    v_lshlrev_b32 v112, 16, v112
    v_mul_f32 v85, v85, v85
    s_mov_b32 s55, 0
    s_waitcnt vmcnt(0)
Lt_52:
    v_xor_b32 v96, s96, v96
    v_xor_b32 v97, s97, v97
    v_xor_b32 v98, s98, v98
    v_xor_b32 v99, s99, v99
    v_xor_b32 v100, s96, v100
    v_xor_b32 v101, s97, v101
    v_xor_b32 v102, s98, v102
    v_xor_b32 v103, s99, v103
    v_xor_b32 v104, s96, v104
    v_xor_b32 v105, s97, v105
    v_xor_b32 v106, s98, v106
    v_xor_b32 v107, s99, v107
    v_or3_b32 v15, v96, v97, v98
    v_or3_b32 v15, v15, v99, v100
    v_or3_b32 v15, v15, v101, v102
    v_or3_b32 v15, v15, v103, v104
    v_or3_b32 v15, v15, v105, v106
    v_or_b32 v15, v15, v107
    s_mov_b32 exec_hi, 0
    v_xor_b32 v108, s96, v108
    v_xor_b32 v109, s97, v109
    v_xor_b32 v110, s98, v110
    v_xor_b32 v111, s99, v111
    v_or3_b32 v15, v15, v108, v109
    v_or3_b32 v15, v15, v110, v111
    s_mov_b32 exec_hi, -1
    v_and_b32 v15, 15, v15
    v_cmp_ne_u32 vcc, 0, v15
    s_cbranch_vccnz Lc_54
Ltok_53:
    v_pk_add_f32 v[96:97], v[96:97], v[100:101]
    v_pk_add_f32 v[104:105], v[104:105], v[108:109]
    v_pk_add_f32 v[98:99], v[98:99], v[102:103]
    v_pk_add_f32 v[106:107], v[106:107], v[110:111]
    v_pk_add_f32 v[96:97], v[96:97], v[104:105]
    v_pk_add_f32 v[98:99], v[98:99], v[106:107]
    s_nop 1
    v_permlane32_swap_b32 v96, v98
    v_permlane32_swap_b32 v97, v99
    s_nop 0
    v_pk_add_f32 v[96:97], v[96:97], v[98:99]
    s_nop 1
    v_permlane16_swap_b32 v96, v97
    s_nop 0
    v_add_f32 v96, v96, v97
    s_nop 1
    v_add_f32_dpp v96, v96, v96 row_ror:8 row_mask:0xf bank_mask:0xf
    v_mul_f32 v96, v96, v85
    v_cvt_pk_bf16_f32 v96, v96, v96
    v_lshlrev_b32 v96, 16, v96
    v_add_f32 v96, v96, v112
    v_cvt_pk_bf16_f32 v96, v96, v96
    s_mov_b32 exec_lo, 0x00ff00ff
    s_mov_b32 exec_hi, 0x00ff00ff
    buffer_store_short v96, v150, s[8:11], s100 offen
    s_mov_b64 exec, -1
L_fin:
L_end:
    s_endpgm
Lc_3:
    s_sleep 2
    s_add_u32 s55, s55, 1
    s_cmp_lt_u32 s55, 40000000
    s_cbranch_scc1 Ls_1
    s_branch Lsok_2
Lc_6:
    s_sleep 2
    s_add_u32 s55, s55, 1
    s_cmp_lt_u32 s55, 40000000
    s_cbranch_scc1 Ls_4
    s_branch Lsok_5
Lc_9:
    s_sleep 1
    s_add_u32 s55, s55, 1
    s_cmp_lt_u32 s55, 40000000
    s_cbranch_scc1 Ls_7
    s_branch Lsok_8
Lc_12:
    s_add_u32 s55, s55, 1
    s_cmp_lt_u32 s55, 40000000
    s_cbranch_scc1 Ls_10
    s_branch Lsok_11
Lc_15:
    s_add_u32 s55, s55, 1
    s_cmp_lt_u32 s55, 40000000
    s_cbranch_scc1 Ls_13
    s_branch Lsok_14
L_o_slow:
    buffer_store_dwordx4 v[112:115], v7, s[24:27], s48 offen sc1
    s_branch L_o_done
Lc_21:
    s_sleep 1
    s_add_u32 s55, s55, 1
    s_cmp_lt_u32 s55, 40000000
    s_cbranch_scc1 Ls_19
    s_branch Lsok_20
Lc_26:
    s_sleep 1
    s_add_u32 s55, s55, 1
    s_cmp_lt_u32 s55, 40000000
    s_cbranch_scc1 Ls_24
    s_branch Lsok_25
Lc_29:
    buffer_load_dwordx4 v[88:91], v14, s[24:27], s58 offen offset:0 sc1
    buffer_load_dwordx4 v[92:95], v14, s[24:27], s58 offen offset:256 sc1
    s_add_u32 s55, s55, 1
    s_cmp_lt_u32 s55, 1000000
    s_waitcnt vmcnt(0)
    s_cbranch_scc1 Lretry_27
    s_branch Lok_28
Lc_32:
    buffer_load_dwordx4 v[48:51], v12, s[24:27], s45 offen sc1
    s_add_u32 s55, s55, 1
    s_cmp_lt_u32 s55, 1000000
    s_waitcnt vmcnt(0)
    s_cbranch_scc1 Lt_30
    s_branch Ltok_31
Lsl_33:
    buffer_store_dword v51, v13, s[24:27], s46 offen sc1
    s_branch Lsd_34
Lsl_35:
    buffer_store_dwordx4 v[52:55], v4, s[24:27], s47 offen sc1
    s_branch Lsd_36
Lc_41:
    s_sleep 1
    s_add_u32 s55, s55, 1
    s_cmp_lt_u32 s55, 40000000
    s_cbranch_scc1 Ls_39
    s_branch Lsok_40
Lsl_42:
    buffer_store_dword v44, v11, s[24:27], s57 offen sc1
    s_branch Lsd_43
L_h2:
    s_add_u32 s55, s55, 1
    s_cmp_ge_u32 s55, 1000000
    s_cbranch_scc1 L_h3
    s_cmp_lg_u32 s12, 0
    s_cbranch_scc1 L_h0
    buffer_load_dwordx4 v[64:67], v14, s[24:27], s58 offen offset:0 sc1
    buffer_load_dwordx4 v[68:71], v14, s[24:27], s58 offen offset:512 sc1
    s_waitcnt vmcnt(0)
    s_branch L_h1
Lc_46:
    buffer_load_dword v80, v6, s[24:27], s30 offen sc1
    s_add_u32 s55, s55, 1
    s_cmp_lt_u32 s55, 1000000
    s_waitcnt vmcnt(0)
    s_cbranch_scc1 Lt_44
    s_branch Ltok_45
L_cs_late:
    buffer_load_dword v80, v6, s[24:27], s30 offen sc1
    v_mov_b32 v81, 0
    s_mov_b32 s55, 0
    s_waitcnt vmcnt(0)
Lt_44:
    v_xor_b32 v80, v149, v80
    v_xor_b32 v81, 0, v81
    v_or_b32 v145, v80, v81
    v_and_b32 v145, 15, v145
    v_cmp_ne_u32 vcc, 0, v145
    s_cbranch_vccnz Lc_46
Ltok_45:
    v_mov_b32 v82, v80
    s_nop 1
    v_permlane16_swap_b32 v80, v82
    s_nop 0
    v_add_f32 v80, v80, v82
    v_mov_b32 v82, v80
    s_nop 1
    v_permlane32_swap_b32 v80, v82
    s_nop 0
    v_add_f32 v80, v80, v82
    v_mul_f32 v80, 0xbb000000, v80
    s_branch L_cs_ok
Lsl_47:
    buffer_store_dwordx4 v[44:47], v4, s[24:27], s47 offen sc1
    s_branch Lsd_48
Lc_51:
    buffer_load_dwordx4 v[88:91], v148, s[24:27], s45 offen offset:0 sc1
    buffer_load_dwordx4 v[92:95], v148, s[24:27], s45 offen offset:2048 sc1
    s_add_u32 s55, s55, 1
    s_cmp_lt_u32 s55, 1000000
    s_waitcnt vmcnt(0)
    s_cbranch_scc1 Lt_49
    s_branch Ltok_50
Lc_54:
    buffer_load_dwordx4 v[96:99], v4, s[24:27], s31 offen offset:0 sc1
    buffer_load_dwordx4 v[100:103], v4, s[24:27], s31 offen offset:1024 sc1
    buffer_load_dwordx4 v[104:107], v4, s[24:27], s31 offen offset:2048 sc1
    buffer_load_dwordx4 v[108:111], v13, s[24:27], s31 offen offset:3072 sc1
    s_add_u32 s55, s55, 1
    s_cmp_lt_u32 s55, 1000000
    s_waitcnt vmcnt(0)
    s_cbranch_scc1 Lt_52
    s_branch Ltok_53
L_last:
    s_endpgm
.section .rodata,"a"
.p2align 6
.amdhsa_kernel sequential_preLN__sliding_block_cached__glu_gated_bilinear__decode_kernel
  .amdhsa_next_free_vgpr 168
  .amdhsa_next_free_sgpr 102
  .amdhsa_accum_offset 168
  .amdhsa_group_segment_fixed_size 0
  .amdhsa_kernarg_size 96
  .amdhsa_user_sgpr_count 2
  .amdhsa_user_sgpr_kernarg_segment_ptr 1
  .amdhsa_system_sgpr_workgroup_id_x 1
  .amdhsa_float_denorm_mode_32 3
.end_amdhsa_kernel
```
